```python
import torch

def _softmax(x, axis=-1):
    return torch.softmax(x, dim=axis)
def _gelu(x):
    return torch.nn.functional.gelu(x, approximate="tanh")
def _silu(x):
    return torch.nn.functional.silu(x)
def _sigmoid(x):
    return torch.sigmoid(x)
def _layernorm(x, axis=-1, eps=1e-5):
    m = x.mean(dim=axis, keepdim=True)
    v = x.var(dim=axis, keepdim=True, unbiased=False)
    return (x - m) / torch.sqrt(v + eps)
def _scatter_add(tgt, idx, src, axis=0):
    return tgt.clone().index_add_(axis, idx, src)
def _segment_sum(src, seg, n):
    out = torch.zeros((n,) + src.shape[1:], dtype=src.dtype)
    return out.index_add_(0, seg, src)
def _pad(x, pw):
    flat = tuple(v for pair in reversed(pw) for v in pair)
    return torch.nn.functional.pad(x, flat)

kernel_name = 'interleave_layers__sliding_local_dilated__moe_arch_mod__prompt'

def setup_inputs():

    _w = (lambda a: (lambda t: t.to(torch.bfloat16) if t.is_floating_point() else t)(torch.as_tensor(a)))
    def _A_setup():
        B, S, D = 1, 2048, 512
        return {
            "x": _w((lambda *s: torch.randn(*s, dtype=torch.bfloat16) * 0.05)(B, S, D)),
            "wqkv": _w((lambda *s: torch.randn(*s, dtype=torch.bfloat16) * 0.05)(D, 3 * D)),
            "wo": _w((lambda *s: torch.randn(*s, dtype=torch.bfloat16) * 0.05)(D, D)),
        }
    _A_in = _A_setup()

    def _B_setup():
        B, S, D, F, C = 1, 2048, 512, 1792, 8
        return {
            "x": _w((lambda *s: torch.randn(*s, dtype=torch.bfloat16) * 0.05)(B, S, D)),
            "w_r": _w((lambda *s: torch.randn(*s, dtype=torch.bfloat16) * 0.05)(D)),
            "w_gate": _w((lambda *s: torch.randn(*s, dtype=torch.bfloat16) * 0.05)(D, F)),
            "w_up": _w((lambda *s: torch.randn(*s, dtype=torch.bfloat16) * 0.05)(D, F)),
            "w_down": _w((lambda *s: torch.randn(*s, dtype=torch.bfloat16) * 0.05)(F, D)),
        }
    _B_in = _B_setup()

    return {
        "A_x": _A_in["x"],
        "A_wqkv": _A_in["wqkv"],
        "A_wo": _A_in["wo"],
        "B_x": _B_in["x"],
        "B_w_r": _B_in["w_r"],
        "B_w_gate": _B_in["w_gate"],
        "B_w_up": _B_in["w_up"],
        "B_w_down": _B_in["w_down"],
    }

def reference(A_x, A_wqkv, A_wo, B_x, B_w_r, B_w_gate, B_w_up, B_w_down):
    def _A_ref(x, wqkv, wo):
        B, S, D = x.shape
        H = 32; Dh = D // H
        W, dil = 8, 2
        qkv = (lambda x, *d: x.permute(*d))((x @ wqkv).reshape(B, S, 3, H, Dh), 2, 0, 3, 1, 4)
        q, k, v = qkv[0], qkv[1], qkv[2]
        scale = Dh ** -0.5
        pos = torch.arange(S)
        off = torch.arange(W) * dil
        idx = pos[:, None] - off[None, :]
        mask = idx >= 0
        idx_c = torch.where(mask, idx, 0).reshape(-1)
        kg = k[:, :, idx_c, :].reshape(B, H, S, W, Dh)
        vg = v[:, :, idx_c, :].reshape(B, H, S, W, Dh)
        logits = torch.einsum("bhsd,bhswd->bhsw", q, kg) * scale
        logits = torch.where(mask[None, None, :, :], logits, -1e9)
        attn = _softmax(logits, axis=-1)
        o = torch.einsum("bhsw,bhswd->bhsd", attn, vg)
        return (lambda x, *d: x.permute(*d))(o, 0, 2, 1, 3).reshape(B, S, D) @ wo

    def _B_ref(x, w_r, w_gate, w_up, w_down):
        B, S, D = x.shape
        C = 8
        r = x @ w_r
        idx = torch.argsort(-r, axis=-1)[:, :C]
        idx_e = (lambda x, n, axis: torch.repeat_interleave(x, n, dim=axis))(idx.reshape(B, C, 1), D, axis=2)
        x_sel = (lambda x, i, axis: torch.take_along_dim(x, i, dim=axis))(x, idx_e, axis=1)
        g = _silu(x_sel @ w_gate)
        u = x_sel @ w_up
        y = (g * u) @ w_down
        r_sel = _sigmoid((lambda x, i, axis: torch.take_along_dim(x, i, dim=axis))(r, idx, axis=1))
        y = y * r_sel.reshape(B, C, 1)
        b_off = (torch.arange(B) * S).reshape(B, 1)
        flat_idx = (idx + b_off).reshape(B * C)
        zero = (x * 0.0).reshape(B * S, D)
        upd = _scatter_add(zero, flat_idx, y.reshape(B * C, D), axis=0)
        return x + upd.reshape(B, S, D)

    x = A_x
    x = x + _A_ref(_layernorm(x, axis=-1), A_wqkv, A_wo)
    x = x + _B_ref(_layernorm(x, axis=-1), B_w_r, B_w_gate, B_w_up, B_w_down)
    x = x + _A_ref(_layernorm(x, axis=-1), A_wqkv, A_wo)
    x = x + _B_ref(_layernorm(x, axis=-1), B_w_r, B_w_gate, B_w_up, B_w_down)
    return x
```

```asm
; @launch kernel=k1l0_kernel grid=(256,1,1) block=(512,1,1) lds=148480
; @launch kernel=k2l0_kernel grid=(256,1,1) block=(512,1,1) lds=131072
; @launch kernel=k3l0_kernel grid=(256,1,1) block=(512,1,1) lds=158464
; @launch kernel=k4l0_kernel grid=(8,1,1) block=(256,1,1) lds=0
; @launch kernel=k1l1_kernel grid=(256,1,1) block=(512,1,1) lds=148480
; @launch kernel=k2l1_kernel grid=(256,1,1) block=(512,1,1) lds=131072
; @launch kernel=k3l1_kernel grid=(256,1,1) block=(512,1,1) lds=158464
; @launch kernel=k4l1_kernel grid=(8,1,1) block=(256,1,1) lds=0
.amdgcn_target "amdgcn-amd-amdhsa--gfx950"
.text
.globl k1l0_kernel
.p2align 8
.type k1l0_kernel,@function
k1l0_kernel:
    s_mov_b32 s98, 0
    s_branch L_k1s_body
.globl k1l1_kernel
.p2align 8
.type k1l1_kernel,@function
k1l1_kernel:
    s_mov_b32 s98, 1
L_k1s_body:
    s_cmp_ge_u32 s2, 256
    s_cbranch_scc1 L_k1s_end
    s_load_dwordx4 s[20:23], s[0:1], 0
    s_load_dwordx2 s[24:25], s[0:1], 80
    s_and_b32 s3, s2, 7
    s_lshr_b32 s26, s2, 3
    s_lshl_b32 s27, s3, 2
    s_and_b32 s30, s26, 3
    s_add_u32 s27, s27, s30
    s_lshr_b32 s28, s26, 2
    v_lshrrev_b32 v1, 6, v0
    s_nop 0
    v_readfirstlane_b32 s29, v1
    v_and_b32 v1, 63, v0
    s_lshl_b32 s32, s28, 7
    s_mov_b32 s40, 0x3b000000
    s_mov_b32 s41, 0x3727c5ac
    s_cmp_lt_u32 s29, 4
    s_cbranch_scc1 L_k1s_mm

    s_sub_u32 s29, s29, 4
    v_and_b32 v0, 255, v0
    s_lshl_b32 s30, s27, 6
    s_sub_u32 s30, s30, 16
    s_mul_i32 s31, s29, 24
    v_lshrrev_b32 v10, 3, v1
    v_add_u32 v10, s31, v10
    v_and_b32 v11, 7, v1

    v_add_u32 v12, 0, v10
    v_bfe_u32 v13, v12, 1, 3
    v_xor_b32 v13, v13, v11
    v_add_u32 v14, s30, v12
    v_lshlrev_b32 v14, 10, v14
    v_lshl_add_u32 v2, v13, 4, v14
    v_cmp_gt_u32 vcc, 80, v12
    v_mov_b32 v13, 0x7ff00000
    s_nop 0
    v_cndmask_b32 v2, v13, v2, vcc
    v_add_u32 v12, 8, v10
    v_bfe_u32 v13, v12, 1, 3
    v_xor_b32 v13, v13, v11
    v_add_u32 v14, s30, v12
    v_lshlrev_b32 v14, 10, v14
    v_lshl_add_u32 v3, v13, 4, v14
    v_cmp_gt_u32 vcc, 80, v12
    v_mov_b32 v13, 0x7ff00000
    s_nop 0
    v_cndmask_b32 v3, v13, v3, vcc
    v_add_u32 v12, 16, v10
    v_bfe_u32 v13, v12, 1, 3
    v_xor_b32 v13, v13, v11
    v_add_u32 v14, s30, v12
    v_lshlrev_b32 v14, 10, v14
    v_lshl_add_u32 v4, v13, 4, v14
    v_cmp_gt_u32 vcc, 80, v12
    v_mov_b32 v13, 0x7ff00000
    s_nop 0
    v_cndmask_b32 v4, v13, v4, vcc
    v_lshrrev_b32 v10, 3, v1
    v_mul_u32_u24 v12, 3072, v10
    v_bfe_u32 v13, v10, 1, 1
    v_lshlrev_b32 v13, 1, v13
    v_xor_b32 v13, v13, v11
    v_lshl_add_u32 v5, v13, 4, v12
    v_xor_b32 v13, 4, v13
    v_lshl_add_u32 v6, v13, 4, v12

    s_mul_i32 s31, s29, 6
    s_add_u32 s34, s31, 0
    s_and_b32 s35, s34, 7
    s_mul_i32 s35, s35, 24576
    s_lshr_b32 s34, s34, 3
    s_lshl_b32 s34, s34, 10
    s_add_u32 s35, s35, s34
    s_add_u32 s46, s35, s32
    s_add_u32 s34, s31, 1
    s_and_b32 s35, s34, 7
    s_mul_i32 s35, s35, 24576
    s_lshr_b32 s34, s34, 3
    s_lshl_b32 s34, s34, 10
    s_add_u32 s35, s35, s34
    s_add_u32 s47, s35, s32
    s_add_u32 s34, s31, 2
    s_and_b32 s35, s34, 7
    s_mul_i32 s35, s35, 24576
    s_lshr_b32 s34, s34, 3
    s_lshl_b32 s34, s34, 10
    s_add_u32 s35, s35, s34
    s_add_u32 s48, s35, s32
    s_add_u32 s34, s31, 3
    s_and_b32 s35, s34, 7
    s_mul_i32 s35, s35, 24576
    s_lshr_b32 s34, s34, 3
    s_lshl_b32 s34, s34, 10
    s_add_u32 s35, s35, s34
    s_add_u32 s49, s35, s32
    s_add_u32 s34, s31, 4
    s_and_b32 s35, s34, 7
    s_mul_i32 s35, s35, 24576
    s_lshr_b32 s34, s34, 3
    s_lshl_b32 s34, s34, 10
    s_add_u32 s35, s35, s34
    s_add_u32 s50, s35, s32
    s_add_u32 s34, s31, 5
    s_and_b32 s35, s34, 7
    s_mul_i32 s35, s35, 24576
    s_lshr_b32 s34, s34, 3
    s_lshl_b32 s34, s34, 10
    s_add_u32 s35, s35, s34
    s_add_u32 s51, s35, s32
    s_mul_i32 s52, s29, 3072
    s_add_u32 s52, s52, 1024
    s_mul_i32 s53, s29, 6144
    s_add_u32 s53, s53, 13312
    v_lshrrev_b32 v10, 3, v0
    v_and_b32 v11, 7, v0
    v_lshlrev_b32 v11, 4, v11
    v_add_u32 v44, 32, v10
    v_lshl_add_u32 v28, v44, 7, v11
    v_add_u32 v28, 1024, v28
    v_add_u32 v45, 64, v10
    v_min_u32 v45, 79, v45
    v_lshl_add_u32 v48, v45, 7, v11
    v_add_u32 v48, 1024, v48

    v_add_u32 v29, 36864, v28
    v_add_u32 v49, 36864, v48
    v_add_u32 v30, 73728, v28
    v_add_u32 v50, 73728, v48
    v_add_u32 v31, 110592, v28
    v_add_u32 v51, 110592, v48
    v_mov_b32 v32, 0
    v_mov_b32 v33, 0
    v_mov_b32 v34, 0
    v_mov_b32 v35, 0
    v_mov_b32 v52, 0
    v_mov_b32 v53, 0
    v_mov_b32 v54, 0
    v_mov_b32 v55, 0
    s_waitcnt lgkmcnt(0)
    s_add_u32 s96, s24, 0x400000
    s_addc_u32 s97, s25, 0
    s_mov_b32 s4, s20
    s_mov_b32 s5, s21
    s_cmp_eq_u32 s98, 0
    s_cselect_b32 s4, s4, s96
    s_cselect_b32 s5, s5, s97
    s_mov_b32 s6, 0x200000
    s_mov_b32 s7, 0x00020000
    s_mov_b32 s8, s22
    s_mov_b32 s9, s23
    s_mov_b32 s10, 0x180000
    s_mov_b32 s11, 0x00020000
    s_add_u32 s16, s24, 0x600000
    s_addc_u32 s17, s25, 0
    s_mov_b32 s18, 0xc000
    s_mov_b32 s19, 0x00020000
    v_lshlrev_b32 v10, 4, v0
    s_lshl_b32 s34, s2, 6
    s_add_u32 s34, s34, 32640
    v_add_u32 v12, s34, v10
    s_lshl_b32 s34, s2, 7
    v_add_u32 v10, s34, v10
    v_cmp_gt_u32 vcc, 12, v0
    v_mov_b32 v11, 0x7ffffff0
    s_nop 0
    v_cndmask_b32 v12, v11, v12, vcc
    v_cmp_gt_u32 vcc, 8, v0
    s_nop 1
    v_cndmask_b32 v10, v12, v10, vcc
    buffer_store_dwordx4 v[32:35], v10, s[16:19], 0 offen

    s_add_u32 s35, s26, 0
    s_and_b32 s35, s35, 7
    s_lshl_b32 s34, s35, 7
    s_mul_i32 s35, s35, 196608
    s_add_u32 m0, s52, 0
    s_nop 0
    buffer_load_dwordx4 v2, s[4:7], s34 offen lds
    s_add_u32 m0, s52, 1024
    s_nop 0
    buffer_load_dwordx4 v3, s[4:7], s34 offen lds
    s_add_u32 m0, s52, 2048
    s_nop 0
    buffer_load_dwordx4 v4, s[4:7], s34 offen lds
    s_add_u32 s34, s46, s35
    s_add_u32 m0, s53, 0
    s_nop 0
    buffer_load_dwordx4 v5, s[8:11], s34 offen lds
    s_add_u32 s34, s47, s35
    s_add_u32 m0, s53, 1024
    s_nop 0
    buffer_load_dwordx4 v6, s[8:11], s34 offen lds
    s_add_u32 s34, s48, s35
    s_add_u32 m0, s53, 2048
    s_nop 0
    buffer_load_dwordx4 v5, s[8:11], s34 offen lds
    s_add_u32 s34, s49, s35
    s_add_u32 m0, s53, 3072
    s_nop 0
    buffer_load_dwordx4 v6, s[8:11], s34 offen lds
    s_add_u32 s34, s50, s35
    s_add_u32 m0, s53, 4096
    s_nop 0
    buffer_load_dwordx4 v5, s[8:11], s34 offen lds
    s_add_u32 s34, s51, s35
    s_add_u32 m0, s53, 5120
    s_nop 0
    buffer_load_dwordx4 v6, s[8:11], s34 offen lds
    s_add_u32 s35, s26, 1
    s_and_b32 s35, s35, 7
    s_lshl_b32 s34, s35, 7
    s_mul_i32 s35, s35, 196608
    s_add_u32 m0, s52, 36864
    s_nop 0
    buffer_load_dwordx4 v2, s[4:7], s34 offen lds
    s_add_u32 m0, s52, 37888
    s_nop 0
    buffer_load_dwordx4 v3, s[4:7], s34 offen lds
    s_add_u32 m0, s52, 38912
    s_nop 0
    buffer_load_dwordx4 v4, s[4:7], s34 offen lds
    s_add_u32 s34, s46, s35
    s_add_u32 m0, s53, 36864
    s_nop 0
    buffer_load_dwordx4 v5, s[8:11], s34 offen lds
    s_add_u32 s34, s47, s35
    s_add_u32 m0, s53, 37888
    s_nop 0
    buffer_load_dwordx4 v6, s[8:11], s34 offen lds
    s_add_u32 s34, s48, s35
    s_add_u32 m0, s53, 38912
    s_nop 0
    buffer_load_dwordx4 v5, s[8:11], s34 offen lds
    s_add_u32 s34, s49, s35
    s_add_u32 m0, s53, 39936
    s_nop 0
    buffer_load_dwordx4 v6, s[8:11], s34 offen lds
    s_add_u32 s34, s50, s35
    s_add_u32 m0, s53, 40960
    s_nop 0
    buffer_load_dwordx4 v5, s[8:11], s34 offen lds
    s_add_u32 s34, s51, s35
    s_add_u32 m0, s53, 41984
    s_nop 0
    buffer_load_dwordx4 v6, s[8:11], s34 offen lds
    s_add_u32 s35, s26, 2
    s_and_b32 s35, s35, 7
    s_lshl_b32 s34, s35, 7
    s_mul_i32 s35, s35, 196608
    s_add_u32 m0, s52, 73728
    s_nop 0
    buffer_load_dwordx4 v2, s[4:7], s34 offen lds
    s_add_u32 m0, s52, 74752
    s_nop 0
    buffer_load_dwordx4 v3, s[4:7], s34 offen lds
    s_add_u32 m0, s52, 75776
    s_nop 0
    buffer_load_dwordx4 v4, s[4:7], s34 offen lds
    s_add_u32 s34, s46, s35
    s_add_u32 m0, s53, 73728
    s_nop 0
    buffer_load_dwordx4 v5, s[8:11], s34 offen lds
    s_add_u32 s34, s47, s35
    s_add_u32 m0, s53, 74752
    s_nop 0
    buffer_load_dwordx4 v6, s[8:11], s34 offen lds
    s_add_u32 s34, s48, s35
    s_add_u32 m0, s53, 75776
    s_nop 0
    buffer_load_dwordx4 v5, s[8:11], s34 offen lds
    s_add_u32 s34, s49, s35
    s_add_u32 m0, s53, 76800
    s_nop 0
    buffer_load_dwordx4 v6, s[8:11], s34 offen lds
    s_add_u32 s34, s50, s35
    s_add_u32 m0, s53, 77824
    s_nop 0
    buffer_load_dwordx4 v5, s[8:11], s34 offen lds
    s_add_u32 s34, s51, s35
    s_add_u32 m0, s53, 78848
    s_nop 0
    buffer_load_dwordx4 v6, s[8:11], s34 offen lds
    s_waitcnt vmcnt(18)
    s_barrier
    s_waitcnt vmcnt(9)
    s_barrier
    s_add_u32 s35, s26, 3
    s_and_b32 s35, s35, 7
    s_lshl_b32 s34, s35, 7
    s_mul_i32 s35, s35, 196608
    s_add_u32 m0, s52, 110592
    s_nop 0
    buffer_load_dwordx4 v2, s[4:7], s34 offen lds
    s_add_u32 m0, s52, 111616
    s_nop 0
    buffer_load_dwordx4 v3, s[4:7], s34 offen lds
    s_add_u32 m0, s52, 112640
    s_nop 0
    buffer_load_dwordx4 v4, s[4:7], s34 offen lds
    s_add_u32 s34, s46, s35
    s_add_u32 m0, s53, 110592
    s_nop 0
    buffer_load_dwordx4 v5, s[8:11], s34 offen lds
    s_add_u32 s34, s47, s35
    s_add_u32 m0, s53, 111616
    s_nop 0
    buffer_load_dwordx4 v6, s[8:11], s34 offen lds
    s_add_u32 s34, s48, s35
    s_add_u32 m0, s53, 112640
    s_nop 0
    buffer_load_dwordx4 v5, s[8:11], s34 offen lds
    s_add_u32 s34, s49, s35
    s_add_u32 m0, s53, 113664
    s_nop 0
    buffer_load_dwordx4 v6, s[8:11], s34 offen lds
    s_add_u32 s34, s50, s35
    s_add_u32 m0, s53, 114688
    s_nop 0
    buffer_load_dwordx4 v5, s[8:11], s34 offen lds
    s_add_u32 s34, s51, s35
    s_add_u32 m0, s53, 115712
    s_nop 0
    buffer_load_dwordx4 v6, s[8:11], s34 offen lds
    ds_read_b128 v[40:43], v28
    ds_read_b128 v[56:59], v48
    s_waitcnt lgkmcnt(0)
    v_lshlrev_b32 v36, 16, v40
    v_and_b32 v37, 0xffff0000, v40
    v_add_f32 v32, v32, v36
    v_add_f32 v33, v33, v37
    v_fma_f32 v34, v36, v36, v34
    v_fma_f32 v35, v37, v37, v35
    v_lshlrev_b32 v36, 16, v41
    v_and_b32 v37, 0xffff0000, v41
    v_add_f32 v32, v32, v36
    v_add_f32 v33, v33, v37
    v_fma_f32 v34, v36, v36, v34
    v_fma_f32 v35, v37, v37, v35
    v_lshlrev_b32 v36, 16, v42
    v_and_b32 v37, 0xffff0000, v42
    v_add_f32 v32, v32, v36
    v_add_f32 v33, v33, v37
    v_fma_f32 v34, v36, v36, v34
    v_fma_f32 v35, v37, v37, v35
    v_lshlrev_b32 v36, 16, v43
    v_and_b32 v37, 0xffff0000, v43
    v_add_f32 v32, v32, v36
    v_add_f32 v33, v33, v37
    v_fma_f32 v34, v36, v36, v34
    v_fma_f32 v35, v37, v37, v35
    v_lshlrev_b32 v36, 16, v56
    v_and_b32 v37, 0xffff0000, v56
    v_add_f32 v52, v52, v36
    v_add_f32 v53, v53, v37
    v_fma_f32 v54, v36, v36, v54
    v_fma_f32 v55, v37, v37, v55
    v_lshlrev_b32 v36, 16, v57
    v_and_b32 v37, 0xffff0000, v57
    v_add_f32 v52, v52, v36
    v_add_f32 v53, v53, v37
    v_fma_f32 v54, v36, v36, v54
    v_fma_f32 v55, v37, v37, v55
    v_lshlrev_b32 v36, 16, v58
    v_and_b32 v37, 0xffff0000, v58
    v_add_f32 v52, v52, v36
    v_add_f32 v53, v53, v37
    v_fma_f32 v54, v36, v36, v54
    v_fma_f32 v55, v37, v37, v55
    v_lshlrev_b32 v36, 16, v59
    v_and_b32 v37, 0xffff0000, v59
    v_add_f32 v52, v52, v36
    v_add_f32 v53, v53, v37
    v_fma_f32 v54, v36, v36, v54
    v_fma_f32 v55, v37, v37, v55
    s_waitcnt vmcnt(9)
    s_barrier
    s_add_u32 s35, s26, 4
    s_and_b32 s35, s35, 7
    s_lshl_b32 s34, s35, 7
    s_mul_i32 s35, s35, 196608
    s_add_u32 m0, s52, 0
    s_nop 0
    buffer_load_dwordx4 v2, s[4:7], s34 offen lds
    s_add_u32 m0, s52, 1024
    s_nop 0
    buffer_load_dwordx4 v3, s[4:7], s34 offen lds
    s_add_u32 m0, s52, 2048
    s_nop 0
    buffer_load_dwordx4 v4, s[4:7], s34 offen lds
    s_add_u32 s34, s46, s35
    s_add_u32 m0, s53, 0
    s_nop 0
    buffer_load_dwordx4 v5, s[8:11], s34 offen lds
    s_add_u32 s34, s47, s35
    s_add_u32 m0, s53, 1024
    s_nop 0
    buffer_load_dwordx4 v6, s[8:11], s34 offen lds
    s_add_u32 s34, s48, s35
    s_add_u32 m0, s53, 2048
    s_nop 0
    buffer_load_dwordx4 v5, s[8:11], s34 offen lds
    s_add_u32 s34, s49, s35
    s_add_u32 m0, s53, 3072
    s_nop 0
    buffer_load_dwordx4 v6, s[8:11], s34 offen lds
    s_add_u32 s34, s50, s35
    s_add_u32 m0, s53, 4096
    s_nop 0
    buffer_load_dwordx4 v5, s[8:11], s34 offen lds
    s_add_u32 s34, s51, s35
    s_add_u32 m0, s53, 5120
    s_nop 0
    buffer_load_dwordx4 v6, s[8:11], s34 offen lds
    ds_read_b128 v[40:43], v29
    ds_read_b128 v[56:59], v49
    s_waitcnt lgkmcnt(0)
    v_lshlrev_b32 v36, 16, v40
    v_and_b32 v37, 0xffff0000, v40
    v_add_f32 v32, v32, v36
    v_add_f32 v33, v33, v37
    v_fma_f32 v34, v36, v36, v34
    v_fma_f32 v35, v37, v37, v35
    v_lshlrev_b32 v36, 16, v41
    v_and_b32 v37, 0xffff0000, v41
    v_add_f32 v32, v32, v36
    v_add_f32 v33, v33, v37
    v_fma_f32 v34, v36, v36, v34
    v_fma_f32 v35, v37, v37, v35
    v_lshlrev_b32 v36, 16, v42
    v_and_b32 v37, 0xffff0000, v42
    v_add_f32 v32, v32, v36
    v_add_f32 v33, v33, v37
    v_fma_f32 v34, v36, v36, v34
    v_fma_f32 v35, v37, v37, v35
    v_lshlrev_b32 v36, 16, v43
    v_and_b32 v37, 0xffff0000, v43
    v_add_f32 v32, v32, v36
    v_add_f32 v33, v33, v37
    v_fma_f32 v34, v36, v36, v34
    v_fma_f32 v35, v37, v37, v35
    v_lshlrev_b32 v36, 16, v56
    v_and_b32 v37, 0xffff0000, v56
    v_add_f32 v52, v52, v36
    v_add_f32 v53, v53, v37
    v_fma_f32 v54, v36, v36, v54
    v_fma_f32 v55, v37, v37, v55
    v_lshlrev_b32 v36, 16, v57
    v_and_b32 v37, 0xffff0000, v57
    v_add_f32 v52, v52, v36
    v_add_f32 v53, v53, v37
    v_fma_f32 v54, v36, v36, v54
    v_fma_f32 v55, v37, v37, v55
    v_lshlrev_b32 v36, 16, v58
    v_and_b32 v37, 0xffff0000, v58
    v_add_f32 v52, v52, v36
    v_add_f32 v53, v53, v37
    v_fma_f32 v54, v36, v36, v54
    v_fma_f32 v55, v37, v37, v55
    v_lshlrev_b32 v36, 16, v59
    v_and_b32 v37, 0xffff0000, v59
    v_add_f32 v52, v52, v36
    v_add_f32 v53, v53, v37
    v_fma_f32 v54, v36, v36, v54
    v_fma_f32 v55, v37, v37, v55
    s_waitcnt vmcnt(9)
    s_barrier
    s_add_u32 s35, s26, 5
    s_and_b32 s35, s35, 7
    s_lshl_b32 s34, s35, 7
    s_mul_i32 s35, s35, 196608
    s_add_u32 m0, s52, 36864
    s_nop 0
    buffer_load_dwordx4 v2, s[4:7], s34 offen lds
    s_add_u32 m0, s52, 37888
    s_nop 0
    buffer_load_dwordx4 v3, s[4:7], s34 offen lds
    s_add_u32 m0, s52, 38912
    s_nop 0
    buffer_load_dwordx4 v4, s[4:7], s34 offen lds
    s_add_u32 s34, s46, s35
    s_add_u32 m0, s53, 36864
    s_nop 0
    buffer_load_dwordx4 v5, s[8:11], s34 offen lds
    s_add_u32 s34, s47, s35
    s_add_u32 m0, s53, 37888
    s_nop 0
    buffer_load_dwordx4 v6, s[8:11], s34 offen lds
    s_add_u32 s34, s48, s35
    s_add_u32 m0, s53, 38912
    s_nop 0
    buffer_load_dwordx4 v5, s[8:11], s34 offen lds
    s_add_u32 s34, s49, s35
    s_add_u32 m0, s53, 39936
    s_nop 0
    buffer_load_dwordx4 v6, s[8:11], s34 offen lds
    s_add_u32 s34, s50, s35
    s_add_u32 m0, s53, 40960
    s_nop 0
    buffer_load_dwordx4 v5, s[8:11], s34 offen lds
    s_add_u32 s34, s51, s35
    s_add_u32 m0, s53, 41984
    s_nop 0
    buffer_load_dwordx4 v6, s[8:11], s34 offen lds
    ds_read_b128 v[40:43], v30
    ds_read_b128 v[56:59], v50
    s_waitcnt lgkmcnt(0)
    v_lshlrev_b32 v36, 16, v40
    v_and_b32 v37, 0xffff0000, v40
    v_add_f32 v32, v32, v36
    v_add_f32 v33, v33, v37
    v_fma_f32 v34, v36, v36, v34
    v_fma_f32 v35, v37, v37, v35
    v_lshlrev_b32 v36, 16, v41
    v_and_b32 v37, 0xffff0000, v41
    v_add_f32 v32, v32, v36
    v_add_f32 v33, v33, v37
    v_fma_f32 v34, v36, v36, v34
    v_fma_f32 v35, v37, v37, v35
    v_lshlrev_b32 v36, 16, v42
    v_and_b32 v37, 0xffff0000, v42
    v_add_f32 v32, v32, v36
    v_add_f32 v33, v33, v37
    v_fma_f32 v34, v36, v36, v34
    v_fma_f32 v35, v37, v37, v35
    v_lshlrev_b32 v36, 16, v43
    v_and_b32 v37, 0xffff0000, v43
    v_add_f32 v32, v32, v36
    v_add_f32 v33, v33, v37
    v_fma_f32 v34, v36, v36, v34
    v_fma_f32 v35, v37, v37, v35
    v_lshlrev_b32 v36, 16, v56
    v_and_b32 v37, 0xffff0000, v56
    v_add_f32 v52, v52, v36
    v_add_f32 v53, v53, v37
    v_fma_f32 v54, v36, v36, v54
    v_fma_f32 v55, v37, v37, v55
    v_lshlrev_b32 v36, 16, v57
    v_and_b32 v37, 0xffff0000, v57
    v_add_f32 v52, v52, v36
    v_add_f32 v53, v53, v37
    v_fma_f32 v54, v36, v36, v54
    v_fma_f32 v55, v37, v37, v55
    v_lshlrev_b32 v36, 16, v58
    v_and_b32 v37, 0xffff0000, v58
    v_add_f32 v52, v52, v36
    v_add_f32 v53, v53, v37
    v_fma_f32 v54, v36, v36, v54
    v_fma_f32 v55, v37, v37, v55
    v_lshlrev_b32 v36, 16, v59
    v_and_b32 v37, 0xffff0000, v59
    v_add_f32 v52, v52, v36
    v_add_f32 v53, v53, v37
    v_fma_f32 v54, v36, v36, v54
    v_fma_f32 v55, v37, v37, v55
    s_waitcnt vmcnt(9)
    s_barrier
    s_add_u32 s35, s26, 6
    s_and_b32 s35, s35, 7
    s_lshl_b32 s34, s35, 7
    s_mul_i32 s35, s35, 196608
    s_add_u32 m0, s52, 73728
    s_nop 0
    buffer_load_dwordx4 v2, s[4:7], s34 offen lds
    s_add_u32 m0, s52, 74752
    s_nop 0
    buffer_load_dwordx4 v3, s[4:7], s34 offen lds
    s_add_u32 m0, s52, 75776
    s_nop 0
    buffer_load_dwordx4 v4, s[4:7], s34 offen lds
    s_add_u32 s34, s46, s35
    s_add_u32 m0, s53, 73728
    s_nop 0
    buffer_load_dwordx4 v5, s[8:11], s34 offen lds
    s_add_u32 s34, s47, s35
    s_add_u32 m0, s53, 74752
    s_nop 0
    buffer_load_dwordx4 v6, s[8:11], s34 offen lds
    s_add_u32 s34, s48, s35
    s_add_u32 m0, s53, 75776
    s_nop 0
    buffer_load_dwordx4 v5, s[8:11], s34 offen lds
    s_add_u32 s34, s49, s35
    s_add_u32 m0, s53, 76800
    s_nop 0
    buffer_load_dwordx4 v6, s[8:11], s34 offen lds
    s_add_u32 s34, s50, s35
    s_add_u32 m0, s53, 77824
    s_nop 0
    buffer_load_dwordx4 v5, s[8:11], s34 offen lds
    s_add_u32 s34, s51, s35
    s_add_u32 m0, s53, 78848
    s_nop 0
    buffer_load_dwordx4 v6, s[8:11], s34 offen lds
    ds_read_b128 v[40:43], v31
    ds_read_b128 v[56:59], v51
    s_waitcnt lgkmcnt(0)
    v_lshlrev_b32 v36, 16, v40
    v_and_b32 v37, 0xffff0000, v40
    v_add_f32 v32, v32, v36
    v_add_f32 v33, v33, v37
    v_fma_f32 v34, v36, v36, v34
    v_fma_f32 v35, v37, v37, v35
    v_lshlrev_b32 v36, 16, v41
    v_and_b32 v37, 0xffff0000, v41
    v_add_f32 v32, v32, v36
    v_add_f32 v33, v33, v37
    v_fma_f32 v34, v36, v36, v34
    v_fma_f32 v35, v37, v37, v35
    v_lshlrev_b32 v36, 16, v42
    v_and_b32 v37, 0xffff0000, v42
    v_add_f32 v32, v32, v36
    v_add_f32 v33, v33, v37
    v_fma_f32 v34, v36, v36, v34
    v_fma_f32 v35, v37, v37, v35
    v_lshlrev_b32 v36, 16, v43
    v_and_b32 v37, 0xffff0000, v43
    v_add_f32 v32, v32, v36
    v_add_f32 v33, v33, v37
    v_fma_f32 v34, v36, v36, v34
    v_fma_f32 v35, v37, v37, v35
    v_lshlrev_b32 v36, 16, v56
    v_and_b32 v37, 0xffff0000, v56
    v_add_f32 v52, v52, v36
    v_add_f32 v53, v53, v37
    v_fma_f32 v54, v36, v36, v54
    v_fma_f32 v55, v37, v37, v55
    v_lshlrev_b32 v36, 16, v57
    v_and_b32 v37, 0xffff0000, v57
    v_add_f32 v52, v52, v36
    v_add_f32 v53, v53, v37
    v_fma_f32 v54, v36, v36, v54
    v_fma_f32 v55, v37, v37, v55
    v_lshlrev_b32 v36, 16, v58
    v_and_b32 v37, 0xffff0000, v58
    v_add_f32 v52, v52, v36
    v_add_f32 v53, v53, v37
    v_fma_f32 v54, v36, v36, v54
    v_fma_f32 v55, v37, v37, v55
    v_lshlrev_b32 v36, 16, v59
    v_and_b32 v37, 0xffff0000, v59
    v_add_f32 v52, v52, v36
    v_add_f32 v53, v53, v37
    v_fma_f32 v54, v36, v36, v54
    v_fma_f32 v55, v37, v37, v55
    s_waitcnt vmcnt(9)
    s_barrier
    s_add_u32 s35, s26, 7
    s_and_b32 s35, s35, 7
    s_lshl_b32 s34, s35, 7
    s_mul_i32 s35, s35, 196608
    s_add_u32 m0, s52, 110592
    s_nop 0
    buffer_load_dwordx4 v2, s[4:7], s34 offen lds
    s_add_u32 m0, s52, 111616
    s_nop 0
    buffer_load_dwordx4 v3, s[4:7], s34 offen lds
    s_add_u32 m0, s52, 112640
    s_nop 0
    buffer_load_dwordx4 v4, s[4:7], s34 offen lds
    s_add_u32 s34, s46, s35
    s_add_u32 m0, s53, 110592
    s_nop 0
    buffer_load_dwordx4 v5, s[8:11], s34 offen lds
    s_add_u32 s34, s47, s35
    s_add_u32 m0, s53, 111616
    s_nop 0
    buffer_load_dwordx4 v6, s[8:11], s34 offen lds
    s_add_u32 s34, s48, s35
    s_add_u32 m0, s53, 112640
    s_nop 0
    buffer_load_dwordx4 v5, s[8:11], s34 offen lds
    s_add_u32 s34, s49, s35
    s_add_u32 m0, s53, 113664
    s_nop 0
    buffer_load_dwordx4 v6, s[8:11], s34 offen lds
    s_add_u32 s34, s50, s35
    s_add_u32 m0, s53, 114688
    s_nop 0
    buffer_load_dwordx4 v5, s[8:11], s34 offen lds
    s_add_u32 s34, s51, s35
    s_add_u32 m0, s53, 115712
    s_nop 0
    buffer_load_dwordx4 v6, s[8:11], s34 offen lds
    ds_read_b128 v[40:43], v28
    ds_read_b128 v[56:59], v48
    s_waitcnt lgkmcnt(0)
    v_lshlrev_b32 v36, 16, v40
    v_and_b32 v37, 0xffff0000, v40
    v_add_f32 v32, v32, v36
    v_add_f32 v33, v33, v37
    v_fma_f32 v34, v36, v36, v34
    v_fma_f32 v35, v37, v37, v35
    v_lshlrev_b32 v36, 16, v41
    v_and_b32 v37, 0xffff0000, v41
    v_add_f32 v32, v32, v36
    v_add_f32 v33, v33, v37
    v_fma_f32 v34, v36, v36, v34
    v_fma_f32 v35, v37, v37, v35
    v_lshlrev_b32 v36, 16, v42
    v_and_b32 v37, 0xffff0000, v42
    v_add_f32 v32, v32, v36
    v_add_f32 v33, v33, v37
    v_fma_f32 v34, v36, v36, v34
    v_fma_f32 v35, v37, v37, v35
    v_lshlrev_b32 v36, 16, v43
    v_and_b32 v37, 0xffff0000, v43
    v_add_f32 v32, v32, v36
    v_add_f32 v33, v33, v37
    v_fma_f32 v34, v36, v36, v34
    v_fma_f32 v35, v37, v37, v35
    v_lshlrev_b32 v36, 16, v56
    v_and_b32 v37, 0xffff0000, v56
    v_add_f32 v52, v52, v36
    v_add_f32 v53, v53, v37
    v_fma_f32 v54, v36, v36, v54
    v_fma_f32 v55, v37, v37, v55
    v_lshlrev_b32 v36, 16, v57
    v_and_b32 v37, 0xffff0000, v57
    v_add_f32 v52, v52, v36
    v_add_f32 v53, v53, v37
    v_fma_f32 v54, v36, v36, v54
    v_fma_f32 v55, v37, v37, v55
    v_lshlrev_b32 v36, 16, v58
    v_and_b32 v37, 0xffff0000, v58
    v_add_f32 v52, v52, v36
    v_add_f32 v53, v53, v37
    v_fma_f32 v54, v36, v36, v54
    v_fma_f32 v55, v37, v37, v55
    v_lshlrev_b32 v36, 16, v59
    v_and_b32 v37, 0xffff0000, v59
    v_add_f32 v52, v52, v36
    v_add_f32 v53, v53, v37
    v_fma_f32 v54, v36, v36, v54
    v_fma_f32 v55, v37, v37, v55
    s_waitcnt vmcnt(9)
    s_barrier
    ds_read_b128 v[40:43], v29
    ds_read_b128 v[56:59], v49
    s_waitcnt lgkmcnt(0)
    v_lshlrev_b32 v36, 16, v40
    v_and_b32 v37, 0xffff0000, v40
    v_add_f32 v32, v32, v36
    v_add_f32 v33, v33, v37
    v_fma_f32 v34, v36, v36, v34
    v_fma_f32 v35, v37, v37, v35
    v_lshlrev_b32 v36, 16, v41
    v_and_b32 v37, 0xffff0000, v41
    v_add_f32 v32, v32, v36
    v_add_f32 v33, v33, v37
    v_fma_f32 v34, v36, v36, v34
    v_fma_f32 v35, v37, v37, v35
    v_lshlrev_b32 v36, 16, v42
    v_and_b32 v37, 0xffff0000, v42
    v_add_f32 v32, v32, v36
    v_add_f32 v33, v33, v37
    v_fma_f32 v34, v36, v36, v34
    v_fma_f32 v35, v37, v37, v35
    v_lshlrev_b32 v36, 16, v43
    v_and_b32 v37, 0xffff0000, v43
    v_add_f32 v32, v32, v36
    v_add_f32 v33, v33, v37
    v_fma_f32 v34, v36, v36, v34
    v_fma_f32 v35, v37, v37, v35
    v_lshlrev_b32 v36, 16, v56
    v_and_b32 v37, 0xffff0000, v56
    v_add_f32 v52, v52, v36
    v_add_f32 v53, v53, v37
    v_fma_f32 v54, v36, v36, v54
    v_fma_f32 v55, v37, v37, v55
    v_lshlrev_b32 v36, 16, v57
    v_and_b32 v37, 0xffff0000, v57
    v_add_f32 v52, v52, v36
    v_add_f32 v53, v53, v37
    v_fma_f32 v54, v36, v36, v54
    v_fma_f32 v55, v37, v37, v55
    v_lshlrev_b32 v36, 16, v58
    v_and_b32 v37, 0xffff0000, v58
    v_add_f32 v52, v52, v36
    v_add_f32 v53, v53, v37
    v_fma_f32 v54, v36, v36, v54
    v_fma_f32 v55, v37, v37, v55
    v_lshlrev_b32 v36, 16, v59
    v_and_b32 v37, 0xffff0000, v59
    v_add_f32 v52, v52, v36
    v_add_f32 v53, v53, v37
    v_fma_f32 v54, v36, v36, v54
    v_fma_f32 v55, v37, v37, v55
    s_waitcnt vmcnt(0)
    s_barrier
    ds_read_b128 v[40:43], v30
    ds_read_b128 v[56:59], v50
    s_waitcnt lgkmcnt(0)
    v_lshlrev_b32 v36, 16, v40
    v_and_b32 v37, 0xffff0000, v40
    v_add_f32 v32, v32, v36
    v_add_f32 v33, v33, v37
    v_fma_f32 v34, v36, v36, v34
    v_fma_f32 v35, v37, v37, v35
    v_lshlrev_b32 v36, 16, v41
    v_and_b32 v37, 0xffff0000, v41
    v_add_f32 v32, v32, v36
    v_add_f32 v33, v33, v37
    v_fma_f32 v34, v36, v36, v34
    v_fma_f32 v35, v37, v37, v35
    v_lshlrev_b32 v36, 16, v42
    v_and_b32 v37, 0xffff0000, v42
    v_add_f32 v32, v32, v36
    v_add_f32 v33, v33, v37
    v_fma_f32 v34, v36, v36, v34
    v_fma_f32 v35, v37, v37, v35
    v_lshlrev_b32 v36, 16, v43
    v_and_b32 v37, 0xffff0000, v43
    v_add_f32 v32, v32, v36
    v_add_f32 v33, v33, v37
    v_fma_f32 v34, v36, v36, v34
    v_fma_f32 v35, v37, v37, v35
    v_lshlrev_b32 v36, 16, v56
    v_and_b32 v37, 0xffff0000, v56
    v_add_f32 v52, v52, v36
    v_add_f32 v53, v53, v37
    v_fma_f32 v54, v36, v36, v54
    v_fma_f32 v55, v37, v37, v55
    v_lshlrev_b32 v36, 16, v57
    v_and_b32 v37, 0xffff0000, v57
    v_add_f32 v52, v52, v36
    v_add_f32 v53, v53, v37
    v_fma_f32 v54, v36, v36, v54
    v_fma_f32 v55, v37, v37, v55
    v_lshlrev_b32 v36, 16, v58
    v_and_b32 v37, 0xffff0000, v58
    v_add_f32 v52, v52, v36
    v_add_f32 v53, v53, v37
    v_fma_f32 v54, v36, v36, v54
    v_fma_f32 v55, v37, v37, v55
    v_lshlrev_b32 v36, 16, v59
    v_and_b32 v37, 0xffff0000, v59
    v_add_f32 v52, v52, v36
    v_add_f32 v53, v53, v37
    v_fma_f32 v54, v36, v36, v54
    v_fma_f32 v55, v37, v37, v55
    s_waitcnt vmcnt(0)
    s_barrier
    ds_read_b128 v[40:43], v31
    ds_read_b128 v[56:59], v51
    s_waitcnt lgkmcnt(0)
    v_lshlrev_b32 v36, 16, v40
    v_and_b32 v37, 0xffff0000, v40
    v_add_f32 v32, v32, v36
    v_add_f32 v33, v33, v37
    v_fma_f32 v34, v36, v36, v34
    v_fma_f32 v35, v37, v37, v35
    v_lshlrev_b32 v36, 16, v41
    v_and_b32 v37, 0xffff0000, v41
    v_add_f32 v32, v32, v36
    v_add_f32 v33, v33, v37
    v_fma_f32 v34, v36, v36, v34
    v_fma_f32 v35, v37, v37, v35
    v_lshlrev_b32 v36, 16, v42
    v_and_b32 v37, 0xffff0000, v42
    v_add_f32 v32, v32, v36
    v_add_f32 v33, v33, v37
    v_fma_f32 v34, v36, v36, v34
    v_fma_f32 v35, v37, v37, v35
    v_lshlrev_b32 v36, 16, v43
    v_and_b32 v37, 0xffff0000, v43
    v_add_f32 v32, v32, v36
    v_add_f32 v33, v33, v37
    v_fma_f32 v34, v36, v36, v34
    v_fma_f32 v35, v37, v37, v35
    v_lshlrev_b32 v36, 16, v56
    v_and_b32 v37, 0xffff0000, v56
    v_add_f32 v52, v52, v36
    v_add_f32 v53, v53, v37
    v_fma_f32 v54, v36, v36, v54
    v_fma_f32 v55, v37, v37, v55
    v_lshlrev_b32 v36, 16, v57
    v_and_b32 v37, 0xffff0000, v57
    v_add_f32 v52, v52, v36
    v_add_f32 v53, v53, v37
    v_fma_f32 v54, v36, v36, v54
    v_fma_f32 v55, v37, v37, v55
    v_lshlrev_b32 v36, 16, v58
    v_and_b32 v37, 0xffff0000, v58
    v_add_f32 v52, v52, v36
    v_add_f32 v53, v53, v37
    v_fma_f32 v54, v36, v36, v54
    v_fma_f32 v55, v37, v37, v55
    v_lshlrev_b32 v36, 16, v59
    v_and_b32 v37, 0xffff0000, v59
    v_add_f32 v52, v52, v36
    v_add_f32 v53, v53, v37
    v_fma_f32 v54, v36, v36, v54
    v_fma_f32 v55, v37, v37, v55
    v_add_f32 v32, v32, v33
    v_add_f32 v34, v34, v35
    s_nop 1
    v_add_f32_dpp v32, v32, v32 quad_perm:[1,0,3,2] row_mask:0xf bank_mask:0xf
    v_add_f32_dpp v34, v34, v34 quad_perm:[1,0,3,2] row_mask:0xf bank_mask:0xf
    s_nop 1
    v_add_f32_dpp v32, v32, v32 quad_perm:[2,3,0,1] row_mask:0xf bank_mask:0xf
    v_add_f32_dpp v34, v34, v34 quad_perm:[2,3,0,1] row_mask:0xf bank_mask:0xf
    s_nop 1
    v_add_f32_dpp v32, v32, v32 row_half_mirror row_mask:0xf bank_mask:0xf
    v_add_f32_dpp v34, v34, v34 row_half_mirror row_mask:0xf bank_mask:0xf
    v_mul_f32 v33, s40, v32
    v_mul_f32 v36, s40, v34
    v_fma_f32 v36, -v33, v33, v36
    v_max_f32 v36, 0, v36
    v_cvt_pk_bf16_f32 v33, v33, v33
    v_lshlrev_b32 v33, 16, v33
    v_cvt_pk_bf16_f32 v36, v36, v36
    v_lshlrev_b32 v36, 16, v36
    v_add_f32 v36, s41, v36
    v_cvt_pk_bf16_f32 v36, v36, v36
    v_lshlrev_b32 v36, 16, v36
    v_sqrt_f32 v36, v36
    s_nop 0
    v_cvt_pk_bf16_f32 v36, v36, v36
    v_lshlrev_b32 v36, 16, v36
    v_rcp_f32 v35, v36
    s_nop 0
    v_lshlrev_b32 v44, 2, v44
    ds_write_b32 v44, v33 offset:0
    ds_write_b32 v44, v35 offset:512
    v_add_f32 v52, v52, v53
    v_add_f32 v54, v54, v55
    s_nop 1
    v_add_f32_dpp v52, v52, v52 quad_perm:[1,0,3,2] row_mask:0xf bank_mask:0xf
    v_add_f32_dpp v54, v54, v54 quad_perm:[1,0,3,2] row_mask:0xf bank_mask:0xf
    s_nop 1
    v_add_f32_dpp v52, v52, v52 quad_perm:[2,3,0,1] row_mask:0xf bank_mask:0xf
    v_add_f32_dpp v54, v54, v54 quad_perm:[2,3,0,1] row_mask:0xf bank_mask:0xf
    s_nop 1
    v_add_f32_dpp v52, v52, v52 row_half_mirror row_mask:0xf bank_mask:0xf
    v_add_f32_dpp v54, v54, v54 row_half_mirror row_mask:0xf bank_mask:0xf
    v_mul_f32 v53, s40, v52
    v_mul_f32 v36, s40, v54
    v_fma_f32 v36, -v53, v53, v36
    v_max_f32 v36, 0, v36
    v_cvt_pk_bf16_f32 v53, v53, v53
    v_lshlrev_b32 v53, 16, v53
    v_cvt_pk_bf16_f32 v36, v36, v36
    v_lshlrev_b32 v36, 16, v36
    v_add_f32 v36, s41, v36
    v_cvt_pk_bf16_f32 v36, v36, v36
    v_lshlrev_b32 v36, 16, v36
    v_sqrt_f32 v36, v36
    s_nop 0
    v_cvt_pk_bf16_f32 v36, v36, v36
    v_lshlrev_b32 v36, 16, v36
    v_rcp_f32 v55, v36
    s_nop 0
    v_lshlrev_b32 v45, 2, v45
    ds_write_b32 v45, v53 offset:0
    ds_write_b32 v45, v55 offset:512
    s_waitcnt lgkmcnt(0)
    s_barrier
    s_endpgm

L_k1s_mm:
    v_and_b32 v10, 15, v1
    v_lshrrev_b32 v11, 4, v1
    v_bfe_u32 v12, v10, 1, 3
    v_xor_b32 v12, v12, v11
    v_lshlrev_b32 v12, 4, v12
    v_lshl_add_u32 v16, v10, 7, v12
    v_add_u32 v16, 1024, v16
    v_xor_b32 v20, 64, v16

    v_bfe_u32 v10, v1, 2, 2
    v_lshl_add_u32 v12, v11, 3, v10
    v_lshlrev_b32 v12, 7, v12
    v_lshrrev_b32 v13, 1, v10
    v_and_b32 v14, 1, v11
    v_lshl_or_b32 v13, v14, 1, v13
    v_xor_b32 v13, s29, v13
    v_lshl_add_u32 v12, v13, 5, v12
    v_and_b32 v13, 3, v1
    v_lshl_add_u32 v24, v13, 3, v12
    v_add_u32 v24, 13312, v24

    v_lshrrev_b32 v172, 3, v0
    v_and_b32 v11, 7, v0
    v_lshlrev_b32 v11, 4, v11
    v_lshl_add_u32 v28, v172, 7, v11
    v_add_u32 v28, 1024, v28

    v_add_u32 v17, 36864, v16
    v_add_u32 v21, 36864, v20
    v_add_u32 v25, 36864, v24
    v_add_u32 v29, 36864, v28
    v_add_u32 v18, 73728, v16
    v_add_u32 v22, 73728, v20
    v_add_u32 v26, 73728, v24
    v_add_u32 v30, 73728, v28
    v_add_u32 v19, 110592, v16
    v_add_u32 v23, 110592, v20
    v_add_u32 v27, 110592, v24
    v_add_u32 v31, 110592, v28
    v_mov_b32 v32, 0
    v_mov_b32 v33, 0
    v_mov_b32 v34, 0
    v_mov_b32 v35, 0
    v_mov_b32 v36, 0x3f803f80
    v_mov_b32 v37, 0x3f803f80
    v_mov_b32 v38, 0x3f803f80
    v_mov_b32 v39, 0x3f803f80
    s_waitcnt lgkmcnt(0)
    s_mov_b32 s12, s24
    s_mov_b32 s13, s25
    s_mov_b32 s14, 0x200000
    s_mov_b32 s15, 0x00020000
    s_barrier
    ds_read_b64_tr_b16 v[80:81], v24 offset:0
    ds_read_b64_tr_b16 v[82:83], v24 offset:512
    ds_read_b64_tr_b16 v[84:85], v24 offset:8192
    ds_read_b64_tr_b16 v[86:87], v24 offset:8704
    ds_read_b64_tr_b16 v[88:89], v24 offset:16384
    ds_read_b64_tr_b16 v[90:91], v24 offset:16896
    ds_read_b128 v[44:47], v16 offset:2048
    ds_read_b128 v[48:51], v16 offset:4096
    ds_read_b128 v[52:55], v16 offset:6144
    ds_read_b128 v[56:59], v16 offset:8192
    ds_read_b128 v[40:43], v16 offset:0
    s_waitcnt lgkmcnt(0)
    v_mfma_f32_16x16x32_bf16 v[104:107], v[80:83], v[44:47], 0
    ds_read_b64_tr_b16 v[92:93], v24 offset:4096
    v_mfma_f32_16x16x32_bf16 v[108:111], v[80:83], v[48:51], 0
    ds_read_b64_tr_b16 v[94:95], v24 offset:4608
    v_mfma_f32_16x16x32_bf16 v[112:115], v[80:83], v[52:55], 0
    ds_read_b64_tr_b16 v[96:97], v24 offset:12288
    v_mfma_f32_16x16x32_bf16 v[116:119], v[80:83], v[56:59], 0
    ds_read_b64_tr_b16 v[98:99], v24 offset:12800
    v_mfma_f32_16x16x32_bf16 v[120:123], v[84:87], v[40:43], 0
    ds_read_b64_tr_b16 v[100:101], v24 offset:20480
    v_mfma_f32_16x16x32_bf16 v[124:127], v[84:87], v[44:47], 0
    ds_read_b64_tr_b16 v[102:103], v24 offset:20992
    v_mfma_f32_16x16x32_bf16 v[128:131], v[84:87], v[48:51], 0
    ds_read_b128 v[64:67], v20 offset:2048
    v_mfma_f32_16x16x32_bf16 v[132:135], v[84:87], v[52:55], 0
    ds_read_b128 v[68:71], v20 offset:4096
    v_mfma_f32_16x16x32_bf16 v[136:139], v[84:87], v[56:59], 0
    ds_read_b128 v[72:75], v20 offset:6144
    v_mfma_f32_16x16x32_bf16 v[140:143], v[40:43], v[88:91], 0
    ds_read_b128 v[76:79], v20 offset:8192
    v_mfma_f32_16x16x32_bf16 v[144:147], v[44:47], v[88:91], 0
    ds_read_b128 v[60:63], v20 offset:0
    v_mfma_f32_16x16x32_bf16 v[148:151], v[48:51], v[88:91], 0
    ds_read_b128 v[176:179], v28
    v_mfma_f32_16x16x32_bf16 v[152:155], v[52:55], v[88:91], 0
    v_mfma_f32_16x16x32_bf16 v[156:159], v[56:59], v[88:91], 0
    v_mfma_f32_16x16x32_bf16 v[160:163], v[80:83], v[36:39], 0
    v_mfma_f32_16x16x32_bf16 v[164:167], v[84:87], v[36:39], 0
    v_mfma_f32_16x16x32_bf16 v[168:171], v[36:39], v[88:91], 0
    s_barrier
    s_waitcnt lgkmcnt(0)
    v_mfma_f32_16x16x32_bf16 v[104:107], v[92:95], v[64:67], v[104:107]
    ds_read_b64_tr_b16 v[80:81], v25 offset:0
    v_mfma_f32_16x16x32_bf16 v[108:111], v[92:95], v[68:71], v[108:111]
    ds_read_b64_tr_b16 v[82:83], v25 offset:512
    v_mfma_f32_16x16x32_bf16 v[112:115], v[92:95], v[72:75], v[112:115]
    ds_read_b64_tr_b16 v[84:85], v25 offset:8192
    v_mfma_f32_16x16x32_bf16 v[116:119], v[92:95], v[76:79], v[116:119]
    ds_read_b64_tr_b16 v[86:87], v25 offset:8704
    v_mfma_f32_16x16x32_bf16 v[120:123], v[96:99], v[60:63], v[120:123]
    ds_read_b64_tr_b16 v[88:89], v25 offset:16384
    v_mfma_f32_16x16x32_bf16 v[124:127], v[96:99], v[64:67], v[124:127]
    ds_read_b64_tr_b16 v[90:91], v25 offset:16896
    v_mfma_f32_16x16x32_bf16 v[128:131], v[96:99], v[68:71], v[128:131]
    ds_read_b128 v[44:47], v17 offset:2048
    v_mfma_f32_16x16x32_bf16 v[132:135], v[96:99], v[72:75], v[132:135]
    ds_read_b128 v[48:51], v17 offset:4096
    v_mfma_f32_16x16x32_bf16 v[136:139], v[96:99], v[76:79], v[136:139]
    ds_read_b128 v[52:55], v17 offset:6144
    v_mfma_f32_16x16x32_bf16 v[140:143], v[60:63], v[100:103], v[140:143]
    ds_read_b128 v[56:59], v17 offset:8192
    v_mfma_f32_16x16x32_bf16 v[144:147], v[64:67], v[100:103], v[144:147]
    ds_read_b128 v[40:43], v17 offset:0
    v_mfma_f32_16x16x32_bf16 v[148:151], v[68:71], v[100:103], v[148:151]
    v_lshlrev_b32 v180, 16, v176
    v_and_b32 v181, 0xffff0000, v176
    v_mfma_f32_16x16x32_bf16 v[152:155], v[72:75], v[100:103], v[152:155]
    v_add_f32 v32, v32, v180
    v_add_f32 v33, v33, v181
    v_mfma_f32_16x16x32_bf16 v[156:159], v[76:79], v[100:103], v[156:159]
    v_fma_f32 v34, v180, v180, v34
    v_fma_f32 v35, v181, v181, v35
    v_mfma_f32_16x16x32_bf16 v[160:163], v[92:95], v[36:39], v[160:163]
    v_lshlrev_b32 v180, 16, v177
    v_and_b32 v181, 0xffff0000, v177
    v_mfma_f32_16x16x32_bf16 v[164:167], v[96:99], v[36:39], v[164:167]
    v_add_f32 v32, v32, v180
    v_add_f32 v33, v33, v181
    v_mfma_f32_16x16x32_bf16 v[168:171], v[36:39], v[100:103], v[168:171]
    v_fma_f32 v34, v180, v180, v34
    v_fma_f32 v35, v181, v181, v35
    v_lshlrev_b32 v180, 16, v178
    v_and_b32 v181, 0xffff0000, v178
    v_add_f32 v32, v32, v180
    v_add_f32 v33, v33, v181
    v_fma_f32 v34, v180, v180, v34
    v_fma_f32 v35, v181, v181, v35
    v_lshlrev_b32 v180, 16, v179
    v_and_b32 v181, 0xffff0000, v179
    v_add_f32 v32, v32, v180
    v_add_f32 v33, v33, v181
    v_fma_f32 v34, v180, v180, v34
    v_fma_f32 v35, v181, v181, v35
    s_barrier
    s_waitcnt lgkmcnt(0)
    v_mfma_f32_16x16x32_bf16 v[104:107], v[80:83], v[44:47], v[104:107]
    ds_read_b64_tr_b16 v[92:93], v25 offset:4096
    v_mfma_f32_16x16x32_bf16 v[108:111], v[80:83], v[48:51], v[108:111]
    ds_read_b64_tr_b16 v[94:95], v25 offset:4608
    v_mfma_f32_16x16x32_bf16 v[112:115], v[80:83], v[52:55], v[112:115]
    ds_read_b64_tr_b16 v[96:97], v25 offset:12288
    v_mfma_f32_16x16x32_bf16 v[116:119], v[80:83], v[56:59], v[116:119]
    ds_read_b64_tr_b16 v[98:99], v25 offset:12800
    v_mfma_f32_16x16x32_bf16 v[120:123], v[84:87], v[40:43], v[120:123]
    ds_read_b64_tr_b16 v[100:101], v25 offset:20480
    v_mfma_f32_16x16x32_bf16 v[124:127], v[84:87], v[44:47], v[124:127]
    ds_read_b64_tr_b16 v[102:103], v25 offset:20992
    v_mfma_f32_16x16x32_bf16 v[128:131], v[84:87], v[48:51], v[128:131]
    ds_read_b128 v[64:67], v21 offset:2048
    v_mfma_f32_16x16x32_bf16 v[132:135], v[84:87], v[52:55], v[132:135]
    ds_read_b128 v[68:71], v21 offset:4096
    v_mfma_f32_16x16x32_bf16 v[136:139], v[84:87], v[56:59], v[136:139]
    ds_read_b128 v[72:75], v21 offset:6144
    v_mfma_f32_16x16x32_bf16 v[140:143], v[40:43], v[88:91], v[140:143]
    ds_read_b128 v[76:79], v21 offset:8192
    v_mfma_f32_16x16x32_bf16 v[144:147], v[44:47], v[88:91], v[144:147]
    ds_read_b128 v[60:63], v21 offset:0
    v_mfma_f32_16x16x32_bf16 v[148:151], v[48:51], v[88:91], v[148:151]
    ds_read_b128 v[176:179], v29
    v_mfma_f32_16x16x32_bf16 v[152:155], v[52:55], v[88:91], v[152:155]
    v_mfma_f32_16x16x32_bf16 v[156:159], v[56:59], v[88:91], v[156:159]
    v_mfma_f32_16x16x32_bf16 v[160:163], v[80:83], v[36:39], v[160:163]
    v_mfma_f32_16x16x32_bf16 v[164:167], v[84:87], v[36:39], v[164:167]
    v_mfma_f32_16x16x32_bf16 v[168:171], v[36:39], v[88:91], v[168:171]
    s_waitcnt lgkmcnt(0)
    v_mfma_f32_16x16x32_bf16 v[104:107], v[92:95], v[64:67], v[104:107]
    ds_read_b64_tr_b16 v[80:81], v26 offset:0
    v_mfma_f32_16x16x32_bf16 v[108:111], v[92:95], v[68:71], v[108:111]
    ds_read_b64_tr_b16 v[82:83], v26 offset:512
    v_mfma_f32_16x16x32_bf16 v[112:115], v[92:95], v[72:75], v[112:115]
    ds_read_b64_tr_b16 v[84:85], v26 offset:8192
    v_mfma_f32_16x16x32_bf16 v[116:119], v[92:95], v[76:79], v[116:119]
    ds_read_b64_tr_b16 v[86:87], v26 offset:8704
    v_mfma_f32_16x16x32_bf16 v[120:123], v[96:99], v[60:63], v[120:123]
    ds_read_b64_tr_b16 v[88:89], v26 offset:16384
    v_mfma_f32_16x16x32_bf16 v[124:127], v[96:99], v[64:67], v[124:127]
    ds_read_b64_tr_b16 v[90:91], v26 offset:16896
    v_mfma_f32_16x16x32_bf16 v[128:131], v[96:99], v[68:71], v[128:131]
    ds_read_b128 v[44:47], v18 offset:2048
    v_mfma_f32_16x16x32_bf16 v[132:135], v[96:99], v[72:75], v[132:135]
    ds_read_b128 v[48:51], v18 offset:4096
    v_mfma_f32_16x16x32_bf16 v[136:139], v[96:99], v[76:79], v[136:139]
    ds_read_b128 v[52:55], v18 offset:6144
    v_mfma_f32_16x16x32_bf16 v[140:143], v[60:63], v[100:103], v[140:143]
    ds_read_b128 v[56:59], v18 offset:8192
    v_mfma_f32_16x16x32_bf16 v[144:147], v[64:67], v[100:103], v[144:147]
    ds_read_b128 v[40:43], v18 offset:0
    v_mfma_f32_16x16x32_bf16 v[148:151], v[68:71], v[100:103], v[148:151]
    v_lshlrev_b32 v180, 16, v176
    v_and_b32 v181, 0xffff0000, v176
    v_mfma_f32_16x16x32_bf16 v[152:155], v[72:75], v[100:103], v[152:155]
    v_add_f32 v32, v32, v180
    v_add_f32 v33, v33, v181
    v_mfma_f32_16x16x32_bf16 v[156:159], v[76:79], v[100:103], v[156:159]
    v_fma_f32 v34, v180, v180, v34
    v_fma_f32 v35, v181, v181, v35
    v_mfma_f32_16x16x32_bf16 v[160:163], v[92:95], v[36:39], v[160:163]
    v_lshlrev_b32 v180, 16, v177
    v_and_b32 v181, 0xffff0000, v177
    v_mfma_f32_16x16x32_bf16 v[164:167], v[96:99], v[36:39], v[164:167]
    v_add_f32 v32, v32, v180
    v_add_f32 v33, v33, v181
    v_mfma_f32_16x16x32_bf16 v[168:171], v[36:39], v[100:103], v[168:171]
    v_fma_f32 v34, v180, v180, v34
    v_fma_f32 v35, v181, v181, v35
    v_lshlrev_b32 v180, 16, v178
    v_and_b32 v181, 0xffff0000, v178
    v_add_f32 v32, v32, v180
    v_add_f32 v33, v33, v181
    v_fma_f32 v34, v180, v180, v34
    v_fma_f32 v35, v181, v181, v35
    v_lshlrev_b32 v180, 16, v179
    v_and_b32 v181, 0xffff0000, v179
    v_add_f32 v32, v32, v180
    v_add_f32 v33, v33, v181
    v_fma_f32 v34, v180, v180, v34
    v_fma_f32 v35, v181, v181, v35
    s_barrier
    s_waitcnt lgkmcnt(0)
    v_mfma_f32_16x16x32_bf16 v[104:107], v[80:83], v[44:47], v[104:107]
    ds_read_b64_tr_b16 v[92:93], v26 offset:4096
    v_mfma_f32_16x16x32_bf16 v[108:111], v[80:83], v[48:51], v[108:111]
    ds_read_b64_tr_b16 v[94:95], v26 offset:4608
    v_mfma_f32_16x16x32_bf16 v[112:115], v[80:83], v[52:55], v[112:115]
    ds_read_b64_tr_b16 v[96:97], v26 offset:12288
    v_mfma_f32_16x16x32_bf16 v[116:119], v[80:83], v[56:59], v[116:119]
    ds_read_b64_tr_b16 v[98:99], v26 offset:12800
    v_mfma_f32_16x16x32_bf16 v[120:123], v[84:87], v[40:43], v[120:123]
    ds_read_b64_tr_b16 v[100:101], v26 offset:20480
    v_mfma_f32_16x16x32_bf16 v[124:127], v[84:87], v[44:47], v[124:127]
    ds_read_b64_tr_b16 v[102:103], v26 offset:20992
    v_mfma_f32_16x16x32_bf16 v[128:131], v[84:87], v[48:51], v[128:131]
    ds_read_b128 v[64:67], v22 offset:2048
    v_mfma_f32_16x16x32_bf16 v[132:135], v[84:87], v[52:55], v[132:135]
    ds_read_b128 v[68:71], v22 offset:4096
    v_mfma_f32_16x16x32_bf16 v[136:139], v[84:87], v[56:59], v[136:139]
    ds_read_b128 v[72:75], v22 offset:6144
    v_mfma_f32_16x16x32_bf16 v[140:143], v[40:43], v[88:91], v[140:143]
    ds_read_b128 v[76:79], v22 offset:8192
    v_mfma_f32_16x16x32_bf16 v[144:147], v[44:47], v[88:91], v[144:147]
    ds_read_b128 v[60:63], v22 offset:0
    v_mfma_f32_16x16x32_bf16 v[148:151], v[48:51], v[88:91], v[148:151]
    ds_read_b128 v[176:179], v30
    v_mfma_f32_16x16x32_bf16 v[152:155], v[52:55], v[88:91], v[152:155]
    v_mfma_f32_16x16x32_bf16 v[156:159], v[56:59], v[88:91], v[156:159]
    v_mfma_f32_16x16x32_bf16 v[160:163], v[80:83], v[36:39], v[160:163]
    v_mfma_f32_16x16x32_bf16 v[164:167], v[84:87], v[36:39], v[164:167]
    v_mfma_f32_16x16x32_bf16 v[168:171], v[36:39], v[88:91], v[168:171]
    s_waitcnt lgkmcnt(0)
    v_mfma_f32_16x16x32_bf16 v[104:107], v[92:95], v[64:67], v[104:107]
    ds_read_b64_tr_b16 v[80:81], v27 offset:0
    v_mfma_f32_16x16x32_bf16 v[108:111], v[92:95], v[68:71], v[108:111]
    ds_read_b64_tr_b16 v[82:83], v27 offset:512
    v_mfma_f32_16x16x32_bf16 v[112:115], v[92:95], v[72:75], v[112:115]
    ds_read_b64_tr_b16 v[84:85], v27 offset:8192
    v_mfma_f32_16x16x32_bf16 v[116:119], v[92:95], v[76:79], v[116:119]
    ds_read_b64_tr_b16 v[86:87], v27 offset:8704
    v_mfma_f32_16x16x32_bf16 v[120:123], v[96:99], v[60:63], v[120:123]
    ds_read_b64_tr_b16 v[88:89], v27 offset:16384
    v_mfma_f32_16x16x32_bf16 v[124:127], v[96:99], v[64:67], v[124:127]
    ds_read_b64_tr_b16 v[90:91], v27 offset:16896
    v_mfma_f32_16x16x32_bf16 v[128:131], v[96:99], v[68:71], v[128:131]
    ds_read_b128 v[44:47], v19 offset:2048
    v_mfma_f32_16x16x32_bf16 v[132:135], v[96:99], v[72:75], v[132:135]
    ds_read_b128 v[48:51], v19 offset:4096
    v_mfma_f32_16x16x32_bf16 v[136:139], v[96:99], v[76:79], v[136:139]
    ds_read_b128 v[52:55], v19 offset:6144
    v_mfma_f32_16x16x32_bf16 v[140:143], v[60:63], v[100:103], v[140:143]
    ds_read_b128 v[56:59], v19 offset:8192
    v_mfma_f32_16x16x32_bf16 v[144:147], v[64:67], v[100:103], v[144:147]
    ds_read_b128 v[40:43], v19 offset:0
    v_mfma_f32_16x16x32_bf16 v[148:151], v[68:71], v[100:103], v[148:151]
    v_lshlrev_b32 v180, 16, v176
    v_and_b32 v181, 0xffff0000, v176
    v_mfma_f32_16x16x32_bf16 v[152:155], v[72:75], v[100:103], v[152:155]
    v_add_f32 v32, v32, v180
    v_add_f32 v33, v33, v181
    v_mfma_f32_16x16x32_bf16 v[156:159], v[76:79], v[100:103], v[156:159]
    v_fma_f32 v34, v180, v180, v34
    v_fma_f32 v35, v181, v181, v35
    v_mfma_f32_16x16x32_bf16 v[160:163], v[92:95], v[36:39], v[160:163]
    v_lshlrev_b32 v180, 16, v177
    v_and_b32 v181, 0xffff0000, v177
    v_mfma_f32_16x16x32_bf16 v[164:167], v[96:99], v[36:39], v[164:167]
    v_add_f32 v32, v32, v180
    v_add_f32 v33, v33, v181
    v_mfma_f32_16x16x32_bf16 v[168:171], v[36:39], v[100:103], v[168:171]
    v_fma_f32 v34, v180, v180, v34
    v_fma_f32 v35, v181, v181, v35
    v_lshlrev_b32 v180, 16, v178
    v_and_b32 v181, 0xffff0000, v178
    v_add_f32 v32, v32, v180
    v_add_f32 v33, v33, v181
    v_fma_f32 v34, v180, v180, v34
    v_fma_f32 v35, v181, v181, v35
    v_lshlrev_b32 v180, 16, v179
    v_and_b32 v181, 0xffff0000, v179
    v_add_f32 v32, v32, v180
    v_add_f32 v33, v33, v181
    v_fma_f32 v34, v180, v180, v34
    v_fma_f32 v35, v181, v181, v35
    s_barrier
    s_waitcnt lgkmcnt(0)
    v_mfma_f32_16x16x32_bf16 v[104:107], v[80:83], v[44:47], v[104:107]
    ds_read_b64_tr_b16 v[92:93], v27 offset:4096
    v_mfma_f32_16x16x32_bf16 v[108:111], v[80:83], v[48:51], v[108:111]
    ds_read_b64_tr_b16 v[94:95], v27 offset:4608
    v_mfma_f32_16x16x32_bf16 v[112:115], v[80:83], v[52:55], v[112:115]
    ds_read_b64_tr_b16 v[96:97], v27 offset:12288
    v_mfma_f32_16x16x32_bf16 v[116:119], v[80:83], v[56:59], v[116:119]
    ds_read_b64_tr_b16 v[98:99], v27 offset:12800
    v_mfma_f32_16x16x32_bf16 v[120:123], v[84:87], v[40:43], v[120:123]
    ds_read_b64_tr_b16 v[100:101], v27 offset:20480
    v_mfma_f32_16x16x32_bf16 v[124:127], v[84:87], v[44:47], v[124:127]
    ds_read_b64_tr_b16 v[102:103], v27 offset:20992
    v_mfma_f32_16x16x32_bf16 v[128:131], v[84:87], v[48:51], v[128:131]
    ds_read_b128 v[64:67], v23 offset:2048
    v_mfma_f32_16x16x32_bf16 v[132:135], v[84:87], v[52:55], v[132:135]
    ds_read_b128 v[68:71], v23 offset:4096
    v_mfma_f32_16x16x32_bf16 v[136:139], v[84:87], v[56:59], v[136:139]
    ds_read_b128 v[72:75], v23 offset:6144
    v_mfma_f32_16x16x32_bf16 v[140:143], v[40:43], v[88:91], v[140:143]
    ds_read_b128 v[76:79], v23 offset:8192
    v_mfma_f32_16x16x32_bf16 v[144:147], v[44:47], v[88:91], v[144:147]
    ds_read_b128 v[60:63], v23 offset:0
    v_mfma_f32_16x16x32_bf16 v[148:151], v[48:51], v[88:91], v[148:151]
    ds_read_b128 v[176:179], v31
    v_mfma_f32_16x16x32_bf16 v[152:155], v[52:55], v[88:91], v[152:155]
    v_mfma_f32_16x16x32_bf16 v[156:159], v[56:59], v[88:91], v[156:159]
    v_mfma_f32_16x16x32_bf16 v[160:163], v[80:83], v[36:39], v[160:163]
    v_mfma_f32_16x16x32_bf16 v[164:167], v[84:87], v[36:39], v[164:167]
    v_mfma_f32_16x16x32_bf16 v[168:171], v[36:39], v[88:91], v[168:171]
    s_waitcnt lgkmcnt(0)
    v_mfma_f32_16x16x32_bf16 v[104:107], v[92:95], v[64:67], v[104:107]
    ds_read_b64_tr_b16 v[80:81], v24 offset:0
    v_mfma_f32_16x16x32_bf16 v[108:111], v[92:95], v[68:71], v[108:111]
    ds_read_b64_tr_b16 v[82:83], v24 offset:512
    v_mfma_f32_16x16x32_bf16 v[112:115], v[92:95], v[72:75], v[112:115]
    ds_read_b64_tr_b16 v[84:85], v24 offset:8192
    v_mfma_f32_16x16x32_bf16 v[116:119], v[92:95], v[76:79], v[116:119]
    ds_read_b64_tr_b16 v[86:87], v24 offset:8704
    v_mfma_f32_16x16x32_bf16 v[120:123], v[96:99], v[60:63], v[120:123]
    ds_read_b64_tr_b16 v[88:89], v24 offset:16384
    v_mfma_f32_16x16x32_bf16 v[124:127], v[96:99], v[64:67], v[124:127]
    ds_read_b64_tr_b16 v[90:91], v24 offset:16896
    v_mfma_f32_16x16x32_bf16 v[128:131], v[96:99], v[68:71], v[128:131]
    ds_read_b128 v[44:47], v16 offset:2048
    v_mfma_f32_16x16x32_bf16 v[132:135], v[96:99], v[72:75], v[132:135]
    ds_read_b128 v[48:51], v16 offset:4096
    v_mfma_f32_16x16x32_bf16 v[136:139], v[96:99], v[76:79], v[136:139]
    ds_read_b128 v[52:55], v16 offset:6144
    v_mfma_f32_16x16x32_bf16 v[140:143], v[60:63], v[100:103], v[140:143]
    ds_read_b128 v[56:59], v16 offset:8192
    v_mfma_f32_16x16x32_bf16 v[144:147], v[64:67], v[100:103], v[144:147]
    ds_read_b128 v[40:43], v16 offset:0
    v_mfma_f32_16x16x32_bf16 v[148:151], v[68:71], v[100:103], v[148:151]
    v_lshlrev_b32 v180, 16, v176
    v_and_b32 v181, 0xffff0000, v176
    v_mfma_f32_16x16x32_bf16 v[152:155], v[72:75], v[100:103], v[152:155]
    v_add_f32 v32, v32, v180
    v_add_f32 v33, v33, v181
    v_mfma_f32_16x16x32_bf16 v[156:159], v[76:79], v[100:103], v[156:159]
    v_fma_f32 v34, v180, v180, v34
    v_fma_f32 v35, v181, v181, v35
    v_mfma_f32_16x16x32_bf16 v[160:163], v[92:95], v[36:39], v[160:163]
    v_lshlrev_b32 v180, 16, v177
    v_and_b32 v181, 0xffff0000, v177
    v_mfma_f32_16x16x32_bf16 v[164:167], v[96:99], v[36:39], v[164:167]
    v_add_f32 v32, v32, v180
    v_add_f32 v33, v33, v181
    v_mfma_f32_16x16x32_bf16 v[168:171], v[36:39], v[100:103], v[168:171]
    v_fma_f32 v34, v180, v180, v34
    v_fma_f32 v35, v181, v181, v35
    v_lshlrev_b32 v180, 16, v178
    v_and_b32 v181, 0xffff0000, v178
    v_add_f32 v32, v32, v180
    v_add_f32 v33, v33, v181
    v_fma_f32 v34, v180, v180, v34
    v_fma_f32 v35, v181, v181, v35
    v_lshlrev_b32 v180, 16, v179
    v_and_b32 v181, 0xffff0000, v179
    v_add_f32 v32, v32, v180
    v_add_f32 v33, v33, v181
    v_fma_f32 v34, v180, v180, v34
    v_fma_f32 v35, v181, v181, v35
    s_barrier
    s_waitcnt lgkmcnt(0)
    v_mfma_f32_16x16x32_bf16 v[104:107], v[80:83], v[44:47], v[104:107]
    ds_read_b64_tr_b16 v[92:93], v24 offset:4096
    v_mfma_f32_16x16x32_bf16 v[108:111], v[80:83], v[48:51], v[108:111]
    ds_read_b64_tr_b16 v[94:95], v24 offset:4608
    v_mfma_f32_16x16x32_bf16 v[112:115], v[80:83], v[52:55], v[112:115]
    ds_read_b64_tr_b16 v[96:97], v24 offset:12288
    v_mfma_f32_16x16x32_bf16 v[116:119], v[80:83], v[56:59], v[116:119]
    ds_read_b64_tr_b16 v[98:99], v24 offset:12800
    v_mfma_f32_16x16x32_bf16 v[120:123], v[84:87], v[40:43], v[120:123]
    ds_read_b64_tr_b16 v[100:101], v24 offset:20480
    v_mfma_f32_16x16x32_bf16 v[124:127], v[84:87], v[44:47], v[124:127]
    ds_read_b64_tr_b16 v[102:103], v24 offset:20992
    v_mfma_f32_16x16x32_bf16 v[128:131], v[84:87], v[48:51], v[128:131]
    ds_read_b128 v[64:67], v20 offset:2048
    v_mfma_f32_16x16x32_bf16 v[132:135], v[84:87], v[52:55], v[132:135]
    ds_read_b128 v[68:71], v20 offset:4096
    v_mfma_f32_16x16x32_bf16 v[136:139], v[84:87], v[56:59], v[136:139]
    ds_read_b128 v[72:75], v20 offset:6144
    v_mfma_f32_16x16x32_bf16 v[140:143], v[40:43], v[88:91], v[140:143]
    ds_read_b128 v[76:79], v20 offset:8192
    v_mfma_f32_16x16x32_bf16 v[144:147], v[44:47], v[88:91], v[144:147]
    ds_read_b128 v[60:63], v20 offset:0
    v_mfma_f32_16x16x32_bf16 v[148:151], v[48:51], v[88:91], v[148:151]
    ds_read_b128 v[176:179], v28
    v_mfma_f32_16x16x32_bf16 v[152:155], v[52:55], v[88:91], v[152:155]
    v_mfma_f32_16x16x32_bf16 v[156:159], v[56:59], v[88:91], v[156:159]
    v_mfma_f32_16x16x32_bf16 v[160:163], v[80:83], v[36:39], v[160:163]
    v_mfma_f32_16x16x32_bf16 v[164:167], v[84:87], v[36:39], v[164:167]
    v_mfma_f32_16x16x32_bf16 v[168:171], v[36:39], v[88:91], v[168:171]
    s_waitcnt lgkmcnt(0)
    v_mfma_f32_16x16x32_bf16 v[104:107], v[92:95], v[64:67], v[104:107]
    ds_read_b64_tr_b16 v[80:81], v25 offset:0
    v_mfma_f32_16x16x32_bf16 v[108:111], v[92:95], v[68:71], v[108:111]
    ds_read_b64_tr_b16 v[82:83], v25 offset:512
    v_mfma_f32_16x16x32_bf16 v[112:115], v[92:95], v[72:75], v[112:115]
    ds_read_b64_tr_b16 v[84:85], v25 offset:8192
    v_mfma_f32_16x16x32_bf16 v[116:119], v[92:95], v[76:79], v[116:119]
    ds_read_b64_tr_b16 v[86:87], v25 offset:8704
    v_mfma_f32_16x16x32_bf16 v[120:123], v[96:99], v[60:63], v[120:123]
    ds_read_b64_tr_b16 v[88:89], v25 offset:16384
    v_mfma_f32_16x16x32_bf16 v[124:127], v[96:99], v[64:67], v[124:127]
    ds_read_b64_tr_b16 v[90:91], v25 offset:16896
    v_mfma_f32_16x16x32_bf16 v[128:131], v[96:99], v[68:71], v[128:131]
    ds_read_b128 v[44:47], v17 offset:2048
    v_mfma_f32_16x16x32_bf16 v[132:135], v[96:99], v[72:75], v[132:135]
    ds_read_b128 v[48:51], v17 offset:4096
    v_mfma_f32_16x16x32_bf16 v[136:139], v[96:99], v[76:79], v[136:139]
    ds_read_b128 v[52:55], v17 offset:6144
    v_mfma_f32_16x16x32_bf16 v[140:143], v[60:63], v[100:103], v[140:143]
    ds_read_b128 v[56:59], v17 offset:8192
    v_mfma_f32_16x16x32_bf16 v[144:147], v[64:67], v[100:103], v[144:147]
    ds_read_b128 v[40:43], v17 offset:0
    v_mfma_f32_16x16x32_bf16 v[148:151], v[68:71], v[100:103], v[148:151]
    v_lshlrev_b32 v180, 16, v176
    v_and_b32 v181, 0xffff0000, v176
    v_mfma_f32_16x16x32_bf16 v[152:155], v[72:75], v[100:103], v[152:155]
    v_add_f32 v32, v32, v180
    v_add_f32 v33, v33, v181
    v_mfma_f32_16x16x32_bf16 v[156:159], v[76:79], v[100:103], v[156:159]
    v_fma_f32 v34, v180, v180, v34
    v_fma_f32 v35, v181, v181, v35
    v_mfma_f32_16x16x32_bf16 v[160:163], v[92:95], v[36:39], v[160:163]
    v_lshlrev_b32 v180, 16, v177
    v_and_b32 v181, 0xffff0000, v177
    v_mfma_f32_16x16x32_bf16 v[164:167], v[96:99], v[36:39], v[164:167]
    v_add_f32 v32, v32, v180
    v_add_f32 v33, v33, v181
    v_mfma_f32_16x16x32_bf16 v[168:171], v[36:39], v[100:103], v[168:171]
    v_fma_f32 v34, v180, v180, v34
    v_fma_f32 v35, v181, v181, v35
    v_lshlrev_b32 v180, 16, v178
    v_and_b32 v181, 0xffff0000, v178
    v_add_f32 v32, v32, v180
    v_add_f32 v33, v33, v181
    v_fma_f32 v34, v180, v180, v34
    v_fma_f32 v35, v181, v181, v35
    v_lshlrev_b32 v180, 16, v179
    v_and_b32 v181, 0xffff0000, v179
    v_add_f32 v32, v32, v180
    v_add_f32 v33, v33, v181
    v_fma_f32 v34, v180, v180, v34
    v_fma_f32 v35, v181, v181, v35
    s_barrier
    s_waitcnt lgkmcnt(0)
    v_mfma_f32_16x16x32_bf16 v[104:107], v[80:83], v[44:47], v[104:107]
    ds_read_b64_tr_b16 v[92:93], v25 offset:4096
    v_mfma_f32_16x16x32_bf16 v[108:111], v[80:83], v[48:51], v[108:111]
    ds_read_b64_tr_b16 v[94:95], v25 offset:4608
    v_mfma_f32_16x16x32_bf16 v[112:115], v[80:83], v[52:55], v[112:115]
    ds_read_b64_tr_b16 v[96:97], v25 offset:12288
    v_mfma_f32_16x16x32_bf16 v[116:119], v[80:83], v[56:59], v[116:119]
    ds_read_b64_tr_b16 v[98:99], v25 offset:12800
    v_mfma_f32_16x16x32_bf16 v[120:123], v[84:87], v[40:43], v[120:123]
    ds_read_b64_tr_b16 v[100:101], v25 offset:20480
    v_mfma_f32_16x16x32_bf16 v[124:127], v[84:87], v[44:47], v[124:127]
    ds_read_b64_tr_b16 v[102:103], v25 offset:20992
    v_mfma_f32_16x16x32_bf16 v[128:131], v[84:87], v[48:51], v[128:131]
    ds_read_b128 v[64:67], v21 offset:2048
    v_mfma_f32_16x16x32_bf16 v[132:135], v[84:87], v[52:55], v[132:135]
    ds_read_b128 v[68:71], v21 offset:4096
    v_mfma_f32_16x16x32_bf16 v[136:139], v[84:87], v[56:59], v[136:139]
    ds_read_b128 v[72:75], v21 offset:6144
    v_mfma_f32_16x16x32_bf16 v[140:143], v[40:43], v[88:91], v[140:143]
    ds_read_b128 v[76:79], v21 offset:8192
    v_mfma_f32_16x16x32_bf16 v[144:147], v[44:47], v[88:91], v[144:147]
    ds_read_b128 v[60:63], v21 offset:0
    v_mfma_f32_16x16x32_bf16 v[148:151], v[48:51], v[88:91], v[148:151]
    ds_read_b128 v[176:179], v29
    v_mfma_f32_16x16x32_bf16 v[152:155], v[52:55], v[88:91], v[152:155]
    v_mfma_f32_16x16x32_bf16 v[156:159], v[56:59], v[88:91], v[156:159]
    v_mfma_f32_16x16x32_bf16 v[160:163], v[80:83], v[36:39], v[160:163]
    v_mfma_f32_16x16x32_bf16 v[164:167], v[84:87], v[36:39], v[164:167]
    v_mfma_f32_16x16x32_bf16 v[168:171], v[36:39], v[88:91], v[168:171]
    s_waitcnt lgkmcnt(0)
    v_mfma_f32_16x16x32_bf16 v[104:107], v[92:95], v[64:67], v[104:107]
    ds_read_b64_tr_b16 v[80:81], v26 offset:0
    v_mfma_f32_16x16x32_bf16 v[108:111], v[92:95], v[68:71], v[108:111]
    ds_read_b64_tr_b16 v[82:83], v26 offset:512
    v_mfma_f32_16x16x32_bf16 v[112:115], v[92:95], v[72:75], v[112:115]
    ds_read_b64_tr_b16 v[84:85], v26 offset:8192
    v_mfma_f32_16x16x32_bf16 v[116:119], v[92:95], v[76:79], v[116:119]
    ds_read_b64_tr_b16 v[86:87], v26 offset:8704
    v_mfma_f32_16x16x32_bf16 v[120:123], v[96:99], v[60:63], v[120:123]
    ds_read_b64_tr_b16 v[88:89], v26 offset:16384
    v_mfma_f32_16x16x32_bf16 v[124:127], v[96:99], v[64:67], v[124:127]
    ds_read_b64_tr_b16 v[90:91], v26 offset:16896
    v_mfma_f32_16x16x32_bf16 v[128:131], v[96:99], v[68:71], v[128:131]
    ds_read_b128 v[44:47], v18 offset:2048
    v_mfma_f32_16x16x32_bf16 v[132:135], v[96:99], v[72:75], v[132:135]
    ds_read_b128 v[48:51], v18 offset:4096
    v_mfma_f32_16x16x32_bf16 v[136:139], v[96:99], v[76:79], v[136:139]
    ds_read_b128 v[52:55], v18 offset:6144
    v_mfma_f32_16x16x32_bf16 v[140:143], v[60:63], v[100:103], v[140:143]
    ds_read_b128 v[56:59], v18 offset:8192
    v_mfma_f32_16x16x32_bf16 v[144:147], v[64:67], v[100:103], v[144:147]
    ds_read_b128 v[40:43], v18 offset:0
    v_mfma_f32_16x16x32_bf16 v[148:151], v[68:71], v[100:103], v[148:151]
    v_lshlrev_b32 v180, 16, v176
    v_and_b32 v181, 0xffff0000, v176
    v_mfma_f32_16x16x32_bf16 v[152:155], v[72:75], v[100:103], v[152:155]
    v_add_f32 v32, v32, v180
    v_add_f32 v33, v33, v181
    v_mfma_f32_16x16x32_bf16 v[156:159], v[76:79], v[100:103], v[156:159]
    v_fma_f32 v34, v180, v180, v34
    v_fma_f32 v35, v181, v181, v35
    v_mfma_f32_16x16x32_bf16 v[160:163], v[92:95], v[36:39], v[160:163]
    v_lshlrev_b32 v180, 16, v177
    v_and_b32 v181, 0xffff0000, v177
    v_mfma_f32_16x16x32_bf16 v[164:167], v[96:99], v[36:39], v[164:167]
    v_add_f32 v32, v32, v180
    v_add_f32 v33, v33, v181
    v_mfma_f32_16x16x32_bf16 v[168:171], v[36:39], v[100:103], v[168:171]
    v_fma_f32 v34, v180, v180, v34
    v_fma_f32 v35, v181, v181, v35
    v_lshlrev_b32 v180, 16, v178
    v_and_b32 v181, 0xffff0000, v178
    v_add_f32 v32, v32, v180
    v_add_f32 v33, v33, v181
    v_fma_f32 v34, v180, v180, v34
    v_fma_f32 v35, v181, v181, v35
    v_lshlrev_b32 v180, 16, v179
    v_and_b32 v181, 0xffff0000, v179
    v_add_f32 v32, v32, v180
    v_add_f32 v33, v33, v181
    v_fma_f32 v34, v180, v180, v34
    v_fma_f32 v35, v181, v181, v35
    s_barrier
    s_waitcnt lgkmcnt(0)
    v_mfma_f32_16x16x32_bf16 v[104:107], v[80:83], v[44:47], v[104:107]
    ds_read_b64_tr_b16 v[92:93], v26 offset:4096
    v_mfma_f32_16x16x32_bf16 v[108:111], v[80:83], v[48:51], v[108:111]
    ds_read_b64_tr_b16 v[94:95], v26 offset:4608
    v_mfma_f32_16x16x32_bf16 v[112:115], v[80:83], v[52:55], v[112:115]
    ds_read_b64_tr_b16 v[96:97], v26 offset:12288
    v_mfma_f32_16x16x32_bf16 v[116:119], v[80:83], v[56:59], v[116:119]
    ds_read_b64_tr_b16 v[98:99], v26 offset:12800
    v_mfma_f32_16x16x32_bf16 v[120:123], v[84:87], v[40:43], v[120:123]
    ds_read_b64_tr_b16 v[100:101], v26 offset:20480
    v_mfma_f32_16x16x32_bf16 v[124:127], v[84:87], v[44:47], v[124:127]
    ds_read_b64_tr_b16 v[102:103], v26 offset:20992
    v_mfma_f32_16x16x32_bf16 v[128:131], v[84:87], v[48:51], v[128:131]
    ds_read_b128 v[64:67], v22 offset:2048
    v_mfma_f32_16x16x32_bf16 v[132:135], v[84:87], v[52:55], v[132:135]
    ds_read_b128 v[68:71], v22 offset:4096
    v_mfma_f32_16x16x32_bf16 v[136:139], v[84:87], v[56:59], v[136:139]
    ds_read_b128 v[72:75], v22 offset:6144
    v_mfma_f32_16x16x32_bf16 v[140:143], v[40:43], v[88:91], v[140:143]
    ds_read_b128 v[76:79], v22 offset:8192
    v_mfma_f32_16x16x32_bf16 v[144:147], v[44:47], v[88:91], v[144:147]
    ds_read_b128 v[60:63], v22 offset:0
    v_mfma_f32_16x16x32_bf16 v[148:151], v[48:51], v[88:91], v[148:151]
    ds_read_b128 v[176:179], v30
    v_mfma_f32_16x16x32_bf16 v[152:155], v[52:55], v[88:91], v[152:155]
    v_mfma_f32_16x16x32_bf16 v[156:159], v[56:59], v[88:91], v[156:159]
    v_mfma_f32_16x16x32_bf16 v[160:163], v[80:83], v[36:39], v[160:163]
    v_mfma_f32_16x16x32_bf16 v[164:167], v[84:87], v[36:39], v[164:167]
    v_mfma_f32_16x16x32_bf16 v[168:171], v[36:39], v[88:91], v[168:171]
    s_waitcnt lgkmcnt(0)
    v_mfma_f32_16x16x32_bf16 v[104:107], v[92:95], v[64:67], v[104:107]
    ds_read_b64_tr_b16 v[80:81], v27 offset:0
    v_mfma_f32_16x16x32_bf16 v[108:111], v[92:95], v[68:71], v[108:111]
    ds_read_b64_tr_b16 v[82:83], v27 offset:512
    v_mfma_f32_16x16x32_bf16 v[112:115], v[92:95], v[72:75], v[112:115]
    ds_read_b64_tr_b16 v[84:85], v27 offset:8192
    v_mfma_f32_16x16x32_bf16 v[116:119], v[92:95], v[76:79], v[116:119]
    ds_read_b64_tr_b16 v[86:87], v27 offset:8704
    v_mfma_f32_16x16x32_bf16 v[120:123], v[96:99], v[60:63], v[120:123]
    ds_read_b64_tr_b16 v[88:89], v27 offset:16384
    v_mfma_f32_16x16x32_bf16 v[124:127], v[96:99], v[64:67], v[124:127]
    ds_read_b64_tr_b16 v[90:91], v27 offset:16896
    v_mfma_f32_16x16x32_bf16 v[128:131], v[96:99], v[68:71], v[128:131]
    ds_read_b128 v[44:47], v19 offset:2048
    v_mfma_f32_16x16x32_bf16 v[132:135], v[96:99], v[72:75], v[132:135]
    ds_read_b128 v[48:51], v19 offset:4096
    v_mfma_f32_16x16x32_bf16 v[136:139], v[96:99], v[76:79], v[136:139]
    ds_read_b128 v[52:55], v19 offset:6144
    v_mfma_f32_16x16x32_bf16 v[140:143], v[60:63], v[100:103], v[140:143]
    ds_read_b128 v[56:59], v19 offset:8192
    v_mfma_f32_16x16x32_bf16 v[144:147], v[64:67], v[100:103], v[144:147]
    ds_read_b128 v[40:43], v19 offset:0
    v_mfma_f32_16x16x32_bf16 v[148:151], v[68:71], v[100:103], v[148:151]
    v_lshlrev_b32 v180, 16, v176
    v_and_b32 v181, 0xffff0000, v176
    v_mfma_f32_16x16x32_bf16 v[152:155], v[72:75], v[100:103], v[152:155]
    v_add_f32 v32, v32, v180
    v_add_f32 v33, v33, v181
    v_mfma_f32_16x16x32_bf16 v[156:159], v[76:79], v[100:103], v[156:159]
    v_fma_f32 v34, v180, v180, v34
    v_fma_f32 v35, v181, v181, v35
    v_mfma_f32_16x16x32_bf16 v[160:163], v[92:95], v[36:39], v[160:163]
    v_lshlrev_b32 v180, 16, v177
    v_and_b32 v181, 0xffff0000, v177
    v_mfma_f32_16x16x32_bf16 v[164:167], v[96:99], v[36:39], v[164:167]
    v_add_f32 v32, v32, v180
    v_add_f32 v33, v33, v181
    v_mfma_f32_16x16x32_bf16 v[168:171], v[36:39], v[100:103], v[168:171]
    v_fma_f32 v34, v180, v180, v34
    v_fma_f32 v35, v181, v181, v35
    v_lshlrev_b32 v180, 16, v178
    v_and_b32 v181, 0xffff0000, v178
    v_add_f32 v32, v32, v180
    v_add_f32 v33, v33, v181
    v_fma_f32 v34, v180, v180, v34
    v_fma_f32 v35, v181, v181, v35
    v_lshlrev_b32 v180, 16, v179
    v_and_b32 v181, 0xffff0000, v179
    v_add_f32 v32, v32, v180
    v_add_f32 v33, v33, v181
    v_fma_f32 v34, v180, v180, v34
    v_fma_f32 v35, v181, v181, v35
    s_barrier
    s_waitcnt lgkmcnt(0)
    v_mfma_f32_16x16x32_bf16 v[104:107], v[80:83], v[44:47], v[104:107]
    ds_read_b64_tr_b16 v[92:93], v27 offset:4096
    v_mfma_f32_16x16x32_bf16 v[108:111], v[80:83], v[48:51], v[108:111]
    ds_read_b64_tr_b16 v[94:95], v27 offset:4608
    v_mfma_f32_16x16x32_bf16 v[112:115], v[80:83], v[52:55], v[112:115]
    ds_read_b64_tr_b16 v[96:97], v27 offset:12288
    v_mfma_f32_16x16x32_bf16 v[116:119], v[80:83], v[56:59], v[116:119]
    ds_read_b64_tr_b16 v[98:99], v27 offset:12800
    v_mfma_f32_16x16x32_bf16 v[120:123], v[84:87], v[40:43], v[120:123]
    ds_read_b64_tr_b16 v[100:101], v27 offset:20480
    v_mfma_f32_16x16x32_bf16 v[124:127], v[84:87], v[44:47], v[124:127]
    ds_read_b64_tr_b16 v[102:103], v27 offset:20992
    v_mfma_f32_16x16x32_bf16 v[128:131], v[84:87], v[48:51], v[128:131]
    ds_read_b128 v[64:67], v23 offset:2048
    v_mfma_f32_16x16x32_bf16 v[132:135], v[84:87], v[52:55], v[132:135]
    ds_read_b128 v[68:71], v23 offset:4096
    v_mfma_f32_16x16x32_bf16 v[136:139], v[84:87], v[56:59], v[136:139]
    ds_read_b128 v[72:75], v23 offset:6144
    v_mfma_f32_16x16x32_bf16 v[140:143], v[40:43], v[88:91], v[140:143]
    ds_read_b128 v[76:79], v23 offset:8192
    v_mfma_f32_16x16x32_bf16 v[144:147], v[44:47], v[88:91], v[144:147]
    ds_read_b128 v[60:63], v23 offset:0
    v_mfma_f32_16x16x32_bf16 v[148:151], v[48:51], v[88:91], v[148:151]
    ds_read_b128 v[176:179], v31
    v_mfma_f32_16x16x32_bf16 v[152:155], v[52:55], v[88:91], v[152:155]
    v_mfma_f32_16x16x32_bf16 v[156:159], v[56:59], v[88:91], v[156:159]
    v_mfma_f32_16x16x32_bf16 v[160:163], v[80:83], v[36:39], v[160:163]
    v_mfma_f32_16x16x32_bf16 v[164:167], v[84:87], v[36:39], v[164:167]
    v_mfma_f32_16x16x32_bf16 v[168:171], v[36:39], v[88:91], v[168:171]
    s_waitcnt lgkmcnt(0)
    v_mfma_f32_16x16x32_bf16 v[104:107], v[92:95], v[64:67], v[104:107]
    v_lshlrev_b32 v180, 16, v176
    v_and_b32 v181, 0xffff0000, v176
    v_mfma_f32_16x16x32_bf16 v[108:111], v[92:95], v[68:71], v[108:111]
    v_add_f32 v32, v32, v180
    v_add_f32 v33, v33, v181
    v_mfma_f32_16x16x32_bf16 v[112:115], v[92:95], v[72:75], v[112:115]
    v_fma_f32 v34, v180, v180, v34
    v_fma_f32 v35, v181, v181, v35
    v_mfma_f32_16x16x32_bf16 v[116:119], v[92:95], v[76:79], v[116:119]
    v_lshlrev_b32 v180, 16, v177
    v_and_b32 v181, 0xffff0000, v177
    v_mfma_f32_16x16x32_bf16 v[120:123], v[96:99], v[60:63], v[120:123]
    v_add_f32 v32, v32, v180
    v_add_f32 v33, v33, v181
    v_mfma_f32_16x16x32_bf16 v[124:127], v[96:99], v[64:67], v[124:127]
    v_fma_f32 v34, v180, v180, v34
    v_fma_f32 v35, v181, v181, v35
    v_mfma_f32_16x16x32_bf16 v[128:131], v[96:99], v[68:71], v[128:131]
    v_lshlrev_b32 v180, 16, v178
    v_and_b32 v181, 0xffff0000, v178
    v_mfma_f32_16x16x32_bf16 v[132:135], v[96:99], v[72:75], v[132:135]
    v_add_f32 v32, v32, v180
    v_add_f32 v33, v33, v181
    v_mfma_f32_16x16x32_bf16 v[136:139], v[96:99], v[76:79], v[136:139]
    v_fma_f32 v34, v180, v180, v34
    v_fma_f32 v35, v181, v181, v35
    v_mfma_f32_16x16x32_bf16 v[140:143], v[60:63], v[100:103], v[140:143]
    v_lshlrev_b32 v180, 16, v179
    v_and_b32 v181, 0xffff0000, v179
    v_mfma_f32_16x16x32_bf16 v[144:147], v[64:67], v[100:103], v[144:147]
    v_add_f32 v32, v32, v180
    v_add_f32 v33, v33, v181
    v_mfma_f32_16x16x32_bf16 v[148:151], v[68:71], v[100:103], v[148:151]
    v_fma_f32 v34, v180, v180, v34
    v_fma_f32 v35, v181, v181, v35
    v_mfma_f32_16x16x32_bf16 v[152:155], v[72:75], v[100:103], v[152:155]
    v_mfma_f32_16x16x32_bf16 v[156:159], v[76:79], v[100:103], v[156:159]
    v_mfma_f32_16x16x32_bf16 v[160:163], v[92:95], v[36:39], v[160:163]
    v_mfma_f32_16x16x32_bf16 v[164:167], v[96:99], v[36:39], v[164:167]
    v_mfma_f32_16x16x32_bf16 v[168:171], v[36:39], v[100:103], v[168:171]
    v_add_f32 v32, v32, v33
    v_add_f32 v34, v34, v35
    s_nop 1
    v_add_f32_dpp v32, v32, v32 quad_perm:[1,0,3,2] row_mask:0xf bank_mask:0xf
    v_add_f32_dpp v34, v34, v34 quad_perm:[1,0,3,2] row_mask:0xf bank_mask:0xf
    s_nop 1
    v_add_f32_dpp v32, v32, v32 quad_perm:[2,3,0,1] row_mask:0xf bank_mask:0xf
    v_add_f32_dpp v34, v34, v34 quad_perm:[2,3,0,1] row_mask:0xf bank_mask:0xf
    s_nop 1
    v_add_f32_dpp v32, v32, v32 row_half_mirror row_mask:0xf bank_mask:0xf
    v_add_f32_dpp v34, v34, v34 row_half_mirror row_mask:0xf bank_mask:0xf
    v_mul_f32 v33, s40, v32
    v_mul_f32 v36, s40, v34
    v_fma_f32 v36, -v33, v33, v36
    v_max_f32 v36, 0, v36
    v_cvt_pk_bf16_f32 v33, v33, v33
    v_lshlrev_b32 v33, 16, v33
    v_cvt_pk_bf16_f32 v36, v36, v36
    v_lshlrev_b32 v36, 16, v36
    v_add_f32 v36, s41, v36
    v_cvt_pk_bf16_f32 v36, v36, v36
    v_lshlrev_b32 v36, 16, v36
    v_sqrt_f32 v36, v36
    s_nop 0
    v_cvt_pk_bf16_f32 v36, v36, v36
    v_lshlrev_b32 v36, 16, v36
    v_rcp_f32 v35, v36
    s_nop 0
    v_lshlrev_b32 v172, 2, v172
    ds_write_b32 v172, v33 offset:0
    ds_write_b32 v172, v35 offset:512
    s_waitcnt lgkmcnt(0)
    s_barrier
    v_and_b32 v10, 15, v1
    v_lshlrev_b32 v10, 2, v10
    v_lshrrev_b32 v11, 4, v1
    v_lshlrev_b32 v11, 4, v11

    ds_read_b32 v40, v10 offset:0
    ds_read_b32 v45, v10 offset:512
    ds_read_b32 v41, v10 offset:64
    ds_read_b32 v46, v10 offset:576
    ds_read_b32 v42, v10 offset:128
    ds_read_b32 v47, v10 offset:640
    ds_read_b32 v43, v10 offset:192
    ds_read_b32 v48, v10 offset:704
    ds_read_b32 v44, v10 offset:256
    ds_read_b32 v49, v10 offset:768
    ds_read_b128 v[52:55], v11 offset:0
    ds_read_b128 v[56:59], v11 offset:512
    ds_read_b128 v[60:63], v11 offset:64
    ds_read_b128 v[64:67], v11 offset:576
    ds_read_b128 v[68:71], v11 offset:128
    ds_read_b128 v[72:75], v11 offset:640
    ds_read_b128 v[76:79], v11 offset:192
    ds_read_b128 v[80:83], v11 offset:704
    ds_read_b128 v[84:87], v11 offset:256
    ds_read_b128 v[88:91], v11 offset:768
    v_and_b32 v188, 15, v1
    v_lshrrev_b32 v189, 4, v1
    v_and_b32 v190, 1, v1
    v_lshl_add_u32 v189, v189, 2, v190
    v_cmp_eq_u32 s[44:45], 1, v190
    v_cmp_le_u32 s[46:47], v189, v188
    v_add_u32 v189, 2, v189
    v_cmp_le_u32 s[48:49], v189, v188
    v_lshlrev_b32 v190, 4, v190
    s_cmp_eq_u32 s27, 0
    s_cselect_b32 s35, 0xf149f2ca, 0
    v_mov_b32 v191, s35
    v_mov_b32 v193, 0
    v_cndmask_b32 v192, v191, v193, s[46:47]
    v_cndmask_b32 v191, v191, v193, s[48:49]
    s_mov_b32 s42, 0x3eb8aa3b

    s_waitcnt lgkmcnt(0)
    v_pk_fma_f32 v[104:105], v[40:41], v[160:161], v[104:105] op_sel:[1,0,0] op_sel_hi:[1,1,1] neg_lo:[1,0,0] neg_hi:[1,0,0]
    v_pk_fma_f32 v[106:107], v[40:41], v[162:163], v[106:107] op_sel:[1,0,0] op_sel_hi:[1,1,1] neg_lo:[1,0,0] neg_hi:[1,0,0]
    v_pk_mul_f32 v[104:105], v[46:47], v[104:105] op_sel:[0,0] op_sel_hi:[0,1]
    v_pk_mul_f32 v[106:107], v[46:47], v[106:107] op_sel:[0,0] op_sel_hi:[0,1]
    v_cvt_pk_bf16_f32 v196, v104, v105
    v_cvt_pk_bf16_f32 v197, v106, v107
    v_pk_fma_f32 v[108:109], v[42:43], v[160:161], v[108:109] op_sel:[0,0,0] op_sel_hi:[0,1,1] neg_lo:[1,0,0] neg_hi:[1,0,0]
    v_pk_fma_f32 v[110:111], v[42:43], v[162:163], v[110:111] op_sel:[0,0,0] op_sel_hi:[0,1,1] neg_lo:[1,0,0] neg_hi:[1,0,0]
    v_pk_mul_f32 v[108:109], v[46:47], v[108:109] op_sel:[1,0] op_sel_hi:[1,1]
    v_pk_mul_f32 v[110:111], v[46:47], v[110:111] op_sel:[1,0] op_sel_hi:[1,1]
    v_cvt_pk_bf16_f32 v198, v108, v109
    v_cvt_pk_bf16_f32 v199, v110, v111
    v_pk_fma_f32 v[112:113], v[42:43], v[160:161], v[112:113] op_sel:[1,0,0] op_sel_hi:[1,1,1] neg_lo:[1,0,0] neg_hi:[1,0,0]
    v_pk_fma_f32 v[114:115], v[42:43], v[162:163], v[114:115] op_sel:[1,0,0] op_sel_hi:[1,1,1] neg_lo:[1,0,0] neg_hi:[1,0,0]
    v_pk_mul_f32 v[112:113], v[48:49], v[112:113] op_sel:[0,0] op_sel_hi:[0,1]
    v_pk_mul_f32 v[114:115], v[48:49], v[114:115] op_sel:[0,0] op_sel_hi:[0,1]
    v_cvt_pk_bf16_f32 v200, v112, v113
    v_cvt_pk_bf16_f32 v201, v114, v115
    v_pk_fma_f32 v[116:117], v[44:45], v[160:161], v[116:117] op_sel:[0,0,0] op_sel_hi:[0,1,1] neg_lo:[1,0,0] neg_hi:[1,0,0]
    v_pk_fma_f32 v[118:119], v[44:45], v[162:163], v[118:119] op_sel:[0,0,0] op_sel_hi:[0,1,1] neg_lo:[1,0,0] neg_hi:[1,0,0]
    v_pk_mul_f32 v[116:117], v[48:49], v[116:117] op_sel:[1,0] op_sel_hi:[1,1]
    v_pk_mul_f32 v[118:119], v[48:49], v[118:119] op_sel:[1,0] op_sel_hi:[1,1]
    v_cvt_pk_bf16_f32 v202, v116, v117
    v_cvt_pk_bf16_f32 v203, v118, v119
    v_pk_fma_f32 v[120:121], v[40:41], v[164:165], v[120:121] op_sel:[0,0,0] op_sel_hi:[0,1,1] neg_lo:[1,0,0] neg_hi:[1,0,0]
    v_pk_fma_f32 v[122:123], v[40:41], v[166:167], v[122:123] op_sel:[0,0,0] op_sel_hi:[0,1,1] neg_lo:[1,0,0] neg_hi:[1,0,0]
    v_pk_mul_f32 v[120:121], v[44:45], v[120:121] op_sel:[1,0] op_sel_hi:[1,1]
    v_pk_mul_f32 v[122:123], v[44:45], v[122:123] op_sel:[1,0] op_sel_hi:[1,1]
    v_cvt_pk_bf16_f32 v204, v120, v121
    v_cvt_pk_bf16_f32 v205, v122, v123
    v_pk_fma_f32 v[124:125], v[40:41], v[164:165], v[124:125] op_sel:[1,0,0] op_sel_hi:[1,1,1] neg_lo:[1,0,0] neg_hi:[1,0,0]
    v_pk_fma_f32 v[126:127], v[40:41], v[166:167], v[126:127] op_sel:[1,0,0] op_sel_hi:[1,1,1] neg_lo:[1,0,0] neg_hi:[1,0,0]
    v_pk_mul_f32 v[124:125], v[46:47], v[124:125] op_sel:[0,0] op_sel_hi:[0,1]
    v_pk_mul_f32 v[126:127], v[46:47], v[126:127] op_sel:[0,0] op_sel_hi:[0,1]
    v_cvt_pk_bf16_f32 v206, v124, v125
    v_cvt_pk_bf16_f32 v207, v126, v127
    v_pk_fma_f32 v[128:129], v[42:43], v[164:165], v[128:129] op_sel:[0,0,0] op_sel_hi:[0,1,1] neg_lo:[1,0,0] neg_hi:[1,0,0]
    v_pk_fma_f32 v[130:131], v[42:43], v[166:167], v[130:131] op_sel:[0,0,0] op_sel_hi:[0,1,1] neg_lo:[1,0,0] neg_hi:[1,0,0]
    v_pk_mul_f32 v[128:129], v[46:47], v[128:129] op_sel:[1,0] op_sel_hi:[1,1]
    v_pk_mul_f32 v[130:131], v[46:47], v[130:131] op_sel:[1,0] op_sel_hi:[1,1]
    v_cvt_pk_bf16_f32 v208, v128, v129
    v_cvt_pk_bf16_f32 v209, v130, v131
    v_pk_fma_f32 v[132:133], v[42:43], v[164:165], v[132:133] op_sel:[1,0,0] op_sel_hi:[1,1,1] neg_lo:[1,0,0] neg_hi:[1,0,0]
    v_pk_fma_f32 v[134:135], v[42:43], v[166:167], v[134:135] op_sel:[1,0,0] op_sel_hi:[1,1,1] neg_lo:[1,0,0] neg_hi:[1,0,0]
    v_pk_mul_f32 v[132:133], v[48:49], v[132:133] op_sel:[0,0] op_sel_hi:[0,1]
    v_pk_mul_f32 v[134:135], v[48:49], v[134:135] op_sel:[0,0] op_sel_hi:[0,1]
    v_cvt_pk_bf16_f32 v210, v132, v133
    v_cvt_pk_bf16_f32 v211, v134, v135
    v_pk_fma_f32 v[136:137], v[44:45], v[164:165], v[136:137] op_sel:[0,0,0] op_sel_hi:[0,1,1] neg_lo:[1,0,0] neg_hi:[1,0,0]
    v_pk_fma_f32 v[138:139], v[44:45], v[166:167], v[138:139] op_sel:[0,0,0] op_sel_hi:[0,1,1] neg_lo:[1,0,0] neg_hi:[1,0,0]
    v_pk_mul_f32 v[136:137], v[48:49], v[136:137] op_sel:[1,0] op_sel_hi:[1,1]
    v_pk_mul_f32 v[138:139], v[48:49], v[138:139] op_sel:[1,0] op_sel_hi:[1,1]
    v_cvt_pk_bf16_f32 v212, v136, v137
    v_cvt_pk_bf16_f32 v213, v138, v139
    v_pk_fma_f32 v[140:141], v[52:53], v[168:169], v[140:141] op_sel:[0,0,0] op_sel_hi:[1,0,1] neg_lo:[1,0,0] neg_hi:[1,0,0]
    v_pk_fma_f32 v[142:143], v[54:55], v[168:169], v[142:143] op_sel:[0,0,0] op_sel_hi:[1,0,1] neg_lo:[1,0,0] neg_hi:[1,0,0]
    v_pk_mul_f32 v[140:141], v[56:57], v[140:141] op_sel:[0,0] op_sel_hi:[1,1]
    v_pk_mul_f32 v[142:143], v[58:59], v[142:143] op_sel:[0,0] op_sel_hi:[1,1]
    v_cvt_pk_bf16_f32 v214, v140, v141
    v_cvt_pk_bf16_f32 v215, v142, v143
    v_pk_fma_f32 v[144:145], v[60:61], v[168:169], v[144:145] op_sel:[0,0,0] op_sel_hi:[1,0,1] neg_lo:[1,0,0] neg_hi:[1,0,0]
    v_pk_fma_f32 v[146:147], v[62:63], v[168:169], v[146:147] op_sel:[0,0,0] op_sel_hi:[1,0,1] neg_lo:[1,0,0] neg_hi:[1,0,0]
    v_pk_mul_f32 v[144:145], v[64:65], v[144:145] op_sel:[0,0] op_sel_hi:[1,1]
    v_pk_mul_f32 v[146:147], v[66:67], v[146:147] op_sel:[0,0] op_sel_hi:[1,1]
    v_cvt_pk_bf16_f32 v216, v144, v145
    v_cvt_pk_bf16_f32 v217, v146, v147
    v_pk_fma_f32 v[148:149], v[68:69], v[168:169], v[148:149] op_sel:[0,0,0] op_sel_hi:[1,0,1] neg_lo:[1,0,0] neg_hi:[1,0,0]
    v_pk_fma_f32 v[150:151], v[70:71], v[168:169], v[150:151] op_sel:[0,0,0] op_sel_hi:[1,0,1] neg_lo:[1,0,0] neg_hi:[1,0,0]
    v_pk_mul_f32 v[148:149], v[72:73], v[148:149] op_sel:[0,0] op_sel_hi:[1,1]
    v_pk_mul_f32 v[150:151], v[74:75], v[150:151] op_sel:[0,0] op_sel_hi:[1,1]
    v_cvt_pk_bf16_f32 v218, v148, v149
    v_cvt_pk_bf16_f32 v219, v150, v151
    v_pk_fma_f32 v[152:153], v[76:77], v[168:169], v[152:153] op_sel:[0,0,0] op_sel_hi:[1,0,1] neg_lo:[1,0,0] neg_hi:[1,0,0]
    v_pk_fma_f32 v[154:155], v[78:79], v[168:169], v[154:155] op_sel:[0,0,0] op_sel_hi:[1,0,1] neg_lo:[1,0,0] neg_hi:[1,0,0]
    v_pk_mul_f32 v[152:153], v[80:81], v[152:153] op_sel:[0,0] op_sel_hi:[1,1]
    v_pk_mul_f32 v[154:155], v[82:83], v[154:155] op_sel:[0,0] op_sel_hi:[1,1]
    v_cvt_pk_bf16_f32 v220, v152, v153
    v_cvt_pk_bf16_f32 v221, v154, v155
    v_pk_fma_f32 v[156:157], v[84:85], v[168:169], v[156:157] op_sel:[0,0,0] op_sel_hi:[1,0,1] neg_lo:[1,0,0] neg_hi:[1,0,0]
    v_pk_fma_f32 v[158:159], v[86:87], v[168:169], v[158:159] op_sel:[0,0,0] op_sel_hi:[1,0,1] neg_lo:[1,0,0] neg_hi:[1,0,0]
    v_pk_mul_f32 v[156:157], v[88:89], v[156:157] op_sel:[0,0] op_sel_hi:[1,1]
    v_pk_mul_f32 v[158:159], v[90:91], v[158:159] op_sel:[0,0] op_sel_hi:[1,1]
    v_cvt_pk_bf16_f32 v222, v156, v157
    v_cvt_pk_bf16_f32 v223, v158, v159
    s_nop 1
    v_mfma_f32_16x16x16_bf16 v[104:107], v[204:205], v[196:197], 0
    v_mfma_f32_16x16x16_bf16 v[108:111], v[206:207], v[196:197], 0
    v_mfma_f32_16x16x16_bf16 v[112:115], v[206:207], v[198:199], 0
    v_mfma_f32_16x16x16_bf16 v[116:119], v[208:209], v[198:199], 0
    v_mfma_f32_16x16x16_bf16 v[120:123], v[208:209], v[200:201], 0
    v_mfma_f32_16x16x16_bf16 v[124:127], v[210:211], v[200:201], 0
    v_mfma_f32_16x16x16_bf16 v[128:131], v[210:211], v[202:203], 0
    v_mfma_f32_16x16x16_bf16 v[132:135], v[212:213], v[202:203], 0
    s_nop 7
    v_cndmask_b32 v194, v108, v109, s[44:45]
    v_cndmask_b32 v195, v104, v105, s[44:45]
    v_cndmask_b32 v140, v195, v194, s[46:47]
    v_cndmask_b32 v194, v110, v111, s[44:45]
    v_cndmask_b32 v195, v106, v107, s[44:45]
    v_cndmask_b32 v141, v195, v194, s[48:49]
    v_cndmask_b32 v194, v116, v117, s[44:45]
    v_cndmask_b32 v195, v112, v113, s[44:45]
    v_cndmask_b32 v142, v195, v194, s[46:47]
    v_cndmask_b32 v194, v118, v119, s[44:45]
    v_cndmask_b32 v195, v114, v115, s[44:45]
    v_cndmask_b32 v143, v195, v194, s[48:49]
    v_cndmask_b32 v194, v124, v125, s[44:45]
    v_cndmask_b32 v195, v120, v121, s[44:45]
    v_cndmask_b32 v144, v195, v194, s[46:47]
    v_cndmask_b32 v194, v126, v127, s[44:45]
    v_cndmask_b32 v195, v122, v123, s[44:45]
    v_cndmask_b32 v145, v195, v194, s[48:49]
    v_cndmask_b32 v194, v132, v133, s[44:45]
    v_cndmask_b32 v195, v128, v129, s[44:45]
    v_cndmask_b32 v146, v195, v194, s[46:47]
    v_cndmask_b32 v194, v134, v135, s[44:45]
    v_cndmask_b32 v195, v130, v131, s[44:45]
    v_cndmask_b32 v147, v195, v194, s[48:49]
    v_cvt_pk_bf16_f32 v194, v140, v141
    v_lshlrev_b32 v140, 16, v194
    v_and_b32 v141, 0xffff0000, v194
    v_fma_f32 v140, v140, s42, v192
    v_fma_f32 v141, v141, s42, v191
    v_max_f32 v148, v140, v141
    v_cvt_pk_bf16_f32 v194, v142, v143
    v_lshlrev_b32 v142, 16, v194
    v_and_b32 v143, 0xffff0000, v194
    v_fma_f32 v142, v142, s42, v193
    v_fma_f32 v143, v143, s42, v193
    v_max_f32 v149, v142, v143
    v_cvt_pk_bf16_f32 v194, v144, v145
    v_lshlrev_b32 v144, 16, v194
    v_and_b32 v145, 0xffff0000, v194
    v_fma_f32 v144, v144, s42, v193
    v_fma_f32 v145, v145, s42, v193
    v_max_f32 v150, v144, v145
    v_cvt_pk_bf16_f32 v194, v146, v147
    v_lshlrev_b32 v146, 16, v194
    v_and_b32 v147, 0xffff0000, v194
    v_fma_f32 v146, v146, s42, v193
    v_fma_f32 v147, v147, s42, v193
    v_max_f32 v151, v146, v147
    v_mov_b32 v152, v148
    v_mov_b32 v153, v149
    v_mov_b32 v154, v150
    v_mov_b32 v155, v151
    s_nop 1
    v_permlane16_swap_b32 v148, v152
    v_permlane16_swap_b32 v149, v153
    v_permlane16_swap_b32 v150, v154
    v_permlane16_swap_b32 v151, v155
    s_nop 0
    v_max_f32 v148, v148, v152
    v_max_f32 v149, v149, v153
    v_max_f32 v150, v150, v154
    v_max_f32 v151, v151, v155
    v_mov_b32 v152, v148
    v_mov_b32 v153, v149
    v_mov_b32 v154, v150
    v_mov_b32 v155, v151
    s_nop 1
    v_permlane32_swap_b32 v148, v152
    v_permlane32_swap_b32 v149, v153
    v_permlane32_swap_b32 v150, v154
    v_permlane32_swap_b32 v151, v155
    s_nop 0
    v_max_f32 v148, v148, v152
    v_max_f32 v149, v149, v153
    v_max_f32 v150, v150, v154
    v_max_f32 v151, v151, v155
    v_sub_f32 v140, v140, v148
    v_sub_f32 v141, v141, v148
    v_exp_f32 v140, v140
    v_exp_f32 v141, v141
    v_sub_f32 v142, v142, v149
    v_sub_f32 v143, v143, v149
    v_exp_f32 v142, v142
    v_exp_f32 v143, v143
    v_sub_f32 v144, v144, v150
    v_sub_f32 v145, v145, v150
    v_exp_f32 v144, v144
    v_exp_f32 v145, v145
    v_sub_f32 v146, v146, v151
    v_sub_f32 v147, v147, v151
    v_exp_f32 v146, v146
    v_exp_f32 v147, v147
    s_nop 0
    v_add_f32 v148, v140, v141
    v_add_f32 v149, v142, v143
    v_add_f32 v150, v144, v145
    v_add_f32 v151, v146, v147
    v_mov_b32 v152, v148
    v_mov_b32 v153, v149
    v_mov_b32 v154, v150
    v_mov_b32 v155, v151
    s_nop 1
    v_permlane16_swap_b32 v148, v152
    v_permlane16_swap_b32 v149, v153
    v_permlane16_swap_b32 v150, v154
    v_permlane16_swap_b32 v151, v155
    s_nop 0
    v_add_f32 v148, v148, v152
    v_add_f32 v149, v149, v153
    v_add_f32 v150, v150, v154
    v_add_f32 v151, v151, v155
    v_mov_b32 v152, v148
    v_mov_b32 v153, v149
    v_mov_b32 v154, v150
    v_mov_b32 v155, v151
    s_nop 1
    v_permlane32_swap_b32 v148, v152
    v_permlane32_swap_b32 v149, v153
    v_permlane32_swap_b32 v150, v154
    v_permlane32_swap_b32 v151, v155
    s_nop 0
    v_add_f32 v148, v148, v152
    v_add_f32 v149, v149, v153
    v_add_f32 v150, v150, v154
    v_add_f32 v151, v151, v155
    v_rcp_f32 v148, v148
    v_rcp_f32 v149, v149
    v_rcp_f32 v150, v150
    v_rcp_f32 v151, v151
    s_nop 0
    v_mul_f32 v140, v140, v148
    v_mul_f32 v141, v141, v148
    v_cvt_pk_bf16_f32 v194, v140, v141
    v_and_b32 v195, 0xffff, v194
    v_lshlrev_b32 v195, v190, v195
    v_lshrrev_b32 v194, 16, v194
    v_lshlrev_b32 v194, v190, v194
    v_cndmask_b32 v156, v195, v193, s[46:47]
    v_cndmask_b32 v157, v194, v193, s[48:49]
    v_cndmask_b32 v158, v193, v195, s[46:47]
    v_cndmask_b32 v159, v193, v194, s[48:49]
    v_mul_f32 v142, v142, v149
    v_mul_f32 v143, v143, v149
    v_cvt_pk_bf16_f32 v194, v142, v143
    v_and_b32 v195, 0xffff, v194
    v_lshlrev_b32 v195, v190, v195
    v_lshrrev_b32 v194, 16, v194
    v_lshlrev_b32 v194, v190, v194
    v_cndmask_b32 v160, v195, v193, s[46:47]
    v_cndmask_b32 v161, v194, v193, s[48:49]
    v_cndmask_b32 v162, v193, v195, s[46:47]
    v_cndmask_b32 v163, v193, v194, s[48:49]
    v_mul_f32 v144, v144, v150
    v_mul_f32 v145, v145, v150
    v_cvt_pk_bf16_f32 v194, v144, v145
    v_and_b32 v195, 0xffff, v194
    v_lshlrev_b32 v195, v190, v195
    v_lshrrev_b32 v194, 16, v194
    v_lshlrev_b32 v194, v190, v194
    v_cndmask_b32 v164, v195, v193, s[46:47]
    v_cndmask_b32 v165, v194, v193, s[48:49]
    v_cndmask_b32 v166, v193, v195, s[46:47]
    v_cndmask_b32 v167, v193, v194, s[48:49]
    v_mul_f32 v146, v146, v151
    v_mul_f32 v147, v147, v151
    v_cvt_pk_bf16_f32 v194, v146, v147
    v_and_b32 v195, 0xffff, v194
    v_lshlrev_b32 v195, v190, v195
    v_lshrrev_b32 v194, 16, v194
    v_lshlrev_b32 v194, v190, v194
    v_cndmask_b32 v168, v195, v193, s[46:47]
    v_cndmask_b32 v169, v194, v193, s[48:49]
    v_cndmask_b32 v170, v193, v195, s[46:47]
    v_cndmask_b32 v171, v193, v194, s[48:49]
    s_nop 1
    v_mfma_f32_16x16x32_bf16 v[172:175], v[214:217], v[156:159], 0
    v_mfma_f32_16x16x32_bf16 v[176:179], v[216:219], v[160:163], 0
    v_mfma_f32_16x16x32_bf16 v[180:183], v[218:221], v[164:167], 0
    v_mfma_f32_16x16x32_bf16 v[184:187], v[220:223], v[168:171], 0
    v_and_b32 v10, 15, v1
    v_lshlrev_b32 v10, 10, v10
    v_lshrrev_b32 v11, 4, v1
    v_lshl_add_u32 v10, v11, 3, v10
    s_lshl_b32 s34, s27, 16
    s_lshl_b32 s35, s29, 5
    s_add_u32 s34, s34, s35
    s_add_u32 s34, s34, s32
    v_add_u32 v10, s34, v10
    s_nop 2

    v_cvt_pk_bf16_f32 v40, v172, v173
    v_cvt_pk_bf16_f32 v41, v174, v175
    s_mov_b32 s34, 0
    buffer_store_dwordx2 v[40:41], v10, s[12:15], s34 offen
    v_cvt_pk_bf16_f32 v42, v176, v177
    v_cvt_pk_bf16_f32 v43, v178, v179
    s_mov_b32 s34, 16384
    buffer_store_dwordx2 v[42:43], v10, s[12:15], s34 offen
    v_cvt_pk_bf16_f32 v44, v180, v181
    v_cvt_pk_bf16_f32 v45, v182, v183
    s_mov_b32 s34, 32768
    buffer_store_dwordx2 v[44:45], v10, s[12:15], s34 offen
    v_cvt_pk_bf16_f32 v46, v184, v185
    v_cvt_pk_bf16_f32 v47, v186, v187
    s_mov_b32 s34, 49152
    buffer_store_dwordx2 v[46:47], v10, s[12:15], s34 offen
L_k1s_end:
    s_endpgm
.section .rodata,"a"
.p2align 6
.amdhsa_kernel k1l0_kernel
  .amdhsa_next_free_vgpr 224
  .amdhsa_next_free_sgpr 102
  .amdhsa_accum_offset 224
  .amdhsa_group_segment_fixed_size 0
  .amdhsa_kernarg_size 88
  .amdhsa_user_sgpr_count 2
  .amdhsa_user_sgpr_kernarg_segment_ptr 1
  .amdhsa_system_sgpr_workgroup_id_x 1
.end_amdhsa_kernel
.section .rodata,"a"
.p2align 6
.amdhsa_kernel k1l1_kernel
  .amdhsa_next_free_vgpr 224
  .amdhsa_next_free_sgpr 102
  .amdhsa_accum_offset 224
  .amdhsa_group_segment_fixed_size 0
  .amdhsa_kernarg_size 88
  .amdhsa_user_sgpr_count 2
  .amdhsa_user_sgpr_kernarg_segment_ptr 1
  .amdhsa_system_sgpr_workgroup_id_x 1
.end_amdhsa_kernel

.text
.globl k2l0_kernel
.p2align 8
.type k2l0_kernel,@function
k2l0_kernel:
    s_mov_b32 s98, 0
    s_branch L_k2s_body
.globl k2l1_kernel
.p2align 8
.type k2l1_kernel,@function
k2l1_kernel:
    s_mov_b32 s98, 1
L_k2s_body:
    s_cmp_ge_u32 s2, 256
    s_cbranch_scc1 L_k2s_end
    s_load_dwordx2 s[20:21], s[0:1], 0
    s_load_dwordx2 s[22:23], s[0:1], 16
    s_load_dwordx2 s[24:25], s[0:1], 80
    s_load_dwordx2 s[36:37], s[0:1], 32
    s_and_b32 s3, s2, 7
    s_lshr_b32 s26, s2, 3
    s_lshl_b32 s27, s3, 2
    s_and_b32 s30, s26, 3
    s_add_u32 s27, s27, s30
    s_lshr_b32 s28, s26, 2
    v_lshrrev_b32 v1, 6, v0
    s_nop 0
    v_readfirstlane_b32 s29, v1
    v_and_b32 v1, 63, v0
    s_cmp_lt_u32 s29, 4
    s_cbranch_scc1 L_k2s_mm

    s_sub_u32 s29, s29, 4
    v_lshrrev_b32 v10, 3, v1
    v_and_b32 v11, 7, v1
    s_lshl_b32 s30, s27, 6
    s_lshl_b32 s31, s29, 4
    s_add_u32 s30, s30, s31
    v_add_u32 v12, s30, v10
    v_lshlrev_b32 v12, 10, v12
    v_lshrrev_b32 v13, 1, v10
    v_xor_b32 v13, v13, v11
    v_lshl_add_u32 v2, v13, 4, v12
    v_xor_b32 v13, 4, v13
    v_add_u32 v12, 8192, v12
    v_lshl_add_u32 v3, v13, 4, v12
    v_add_u32 v12, s31, v10
    v_lshlrev_b32 v12, 10, v12
    s_lshl_b32 s32, s28, 7
    v_add_u32 v12, s32, v12
    v_bfe_u32 v13, v10, 1, 1
    v_lshlrev_b32 v13, 1, v13
    v_xor_b32 v13, v13, v11
    v_lshl_add_u32 v4, v13, 4, v12
    v_xor_b32 v13, 4, v13
    v_add_u32 v12, 8192, v12
    v_lshl_add_u32 v5, v13, 4, v12
    s_lshl_b32 s52, s29, 11

    s_waitcnt lgkmcnt(0)
    s_mov_b32 s4, s24
    s_mov_b32 s5, s25
    s_mov_b32 s6, 0x200000
    s_mov_b32 s7, 0x00020000
    s_mov_b32 s8, s22
    s_mov_b32 s9, s23
    s_mov_b32 s10, 0x80000
    s_mov_b32 s11, 0x00020000
    s_add_u32 s35, s26, 0
    s_and_b32 s35, s35, 7
    s_lshl_b32 s34, s35, 7
    s_lshl_b32 s35, s35, 16
    s_add_u32 m0, s52, 0
    s_nop 0
    buffer_load_dwordx4 v2, s[4:7], s34 offen lds
    s_add_u32 m0, s52, 1024
    s_nop 0
    buffer_load_dwordx4 v3, s[4:7], s34 offen lds
    s_add_u32 m0, s52, 8192
    s_nop 0
    buffer_load_dwordx4 v4, s[8:11], s35 offen lds
    s_add_u32 m0, s52, 9216
    s_nop 0
    buffer_load_dwordx4 v5, s[8:11], s35 offen lds
    s_add_u32 s35, s26, 1
    s_and_b32 s35, s35, 7
    s_lshl_b32 s34, s35, 7
    s_lshl_b32 s35, s35, 16
    s_add_u32 m0, s52, 16384
    s_nop 0
    buffer_load_dwordx4 v2, s[4:7], s34 offen lds
    s_add_u32 m0, s52, 17408
    s_nop 0
    buffer_load_dwordx4 v3, s[4:7], s34 offen lds
    s_add_u32 m0, s52, 24576
    s_nop 0
    buffer_load_dwordx4 v4, s[8:11], s35 offen lds
    s_add_u32 m0, s52, 25600
    s_nop 0
    buffer_load_dwordx4 v5, s[8:11], s35 offen lds
    s_add_u32 s35, s26, 2
    s_and_b32 s35, s35, 7
    s_lshl_b32 s34, s35, 7
    s_lshl_b32 s35, s35, 16
    s_add_u32 m0, s52, 32768
    s_nop 0
    buffer_load_dwordx4 v2, s[4:7], s34 offen lds
    s_add_u32 m0, s52, 33792
    s_nop 0
    buffer_load_dwordx4 v3, s[4:7], s34 offen lds
    s_add_u32 m0, s52, 40960
    s_nop 0
    buffer_load_dwordx4 v4, s[8:11], s35 offen lds
    s_add_u32 m0, s52, 41984
    s_nop 0
    buffer_load_dwordx4 v5, s[8:11], s35 offen lds
    s_add_u32 s35, s26, 3
    s_and_b32 s35, s35, 7
    s_lshl_b32 s34, s35, 7
    s_lshl_b32 s35, s35, 16
    s_add_u32 m0, s52, 49152
    s_nop 0
    buffer_load_dwordx4 v2, s[4:7], s34 offen lds
    s_add_u32 m0, s52, 50176
    s_nop 0
    buffer_load_dwordx4 v3, s[4:7], s34 offen lds
    s_add_u32 m0, s52, 57344
    s_nop 0
    buffer_load_dwordx4 v4, s[8:11], s35 offen lds
    s_add_u32 m0, s52, 58368
    s_nop 0
    buffer_load_dwordx4 v5, s[8:11], s35 offen lds
    s_add_u32 s35, s26, 4
    s_and_b32 s35, s35, 7
    s_lshl_b32 s34, s35, 7
    s_lshl_b32 s35, s35, 16
    s_add_u32 m0, s52, 65536
    s_nop 0
    buffer_load_dwordx4 v2, s[4:7], s34 offen lds
    s_add_u32 m0, s52, 66560
    s_nop 0
    buffer_load_dwordx4 v3, s[4:7], s34 offen lds
    s_add_u32 m0, s52, 73728
    s_nop 0
    buffer_load_dwordx4 v4, s[8:11], s35 offen lds
    s_add_u32 m0, s52, 74752
    s_nop 0
    buffer_load_dwordx4 v5, s[8:11], s35 offen lds
    s_add_u32 s35, s26, 5
    s_and_b32 s35, s35, 7
    s_lshl_b32 s34, s35, 7
    s_lshl_b32 s35, s35, 16
    s_add_u32 m0, s52, 81920
    s_nop 0
    buffer_load_dwordx4 v2, s[4:7], s34 offen lds
    s_add_u32 m0, s52, 82944
    s_nop 0
    buffer_load_dwordx4 v3, s[4:7], s34 offen lds
    s_add_u32 m0, s52, 90112
    s_nop 0
    buffer_load_dwordx4 v4, s[8:11], s35 offen lds
    s_add_u32 m0, s52, 91136
    s_nop 0
    buffer_load_dwordx4 v5, s[8:11], s35 offen lds
    s_add_u32 s35, s26, 6
    s_and_b32 s35, s35, 7
    s_lshl_b32 s34, s35, 7
    s_lshl_b32 s35, s35, 16
    s_add_u32 m0, s52, 98304
    s_nop 0
    buffer_load_dwordx4 v2, s[4:7], s34 offen lds
    s_add_u32 m0, s52, 99328
    s_nop 0
    buffer_load_dwordx4 v3, s[4:7], s34 offen lds
    s_add_u32 m0, s52, 106496
    s_nop 0
    buffer_load_dwordx4 v4, s[8:11], s35 offen lds
    s_add_u32 m0, s52, 107520
    s_nop 0
    buffer_load_dwordx4 v5, s[8:11], s35 offen lds
    s_add_u32 s35, s26, 7
    s_and_b32 s35, s35, 7
    s_lshl_b32 s34, s35, 7
    s_lshl_b32 s35, s35, 16
    s_add_u32 m0, s52, 114688
    s_nop 0
    buffer_load_dwordx4 v2, s[4:7], s34 offen lds
    s_add_u32 m0, s52, 115712
    s_nop 0
    buffer_load_dwordx4 v3, s[4:7], s34 offen lds
    s_add_u32 m0, s52, 122880
    s_nop 0
    buffer_load_dwordx4 v4, s[8:11], s35 offen lds
    s_add_u32 m0, s52, 123904
    s_nop 0
    buffer_load_dwordx4 v5, s[8:11], s35 offen lds
    s_waitcnt vmcnt(24)
    s_barrier
    s_waitcnt vmcnt(16)
    s_barrier
    s_waitcnt vmcnt(8)
    s_barrier
    s_waitcnt vmcnt(0)
    s_barrier
    s_endpgm
L_k2s_mm:
    s_lshr_b32 s30, s29, 1
    s_and_b32 s31, s29, 1
    v_and_b32 v10, 15, v1
    v_lshrrev_b32 v11, 4, v1
    v_bfe_u32 v12, v10, 1, 3
    v_xor_b32 v12, v12, v11
    v_lshlrev_b32 v12, 4, v12
    v_lshl_add_u32 v16, v10, 7, v12
    s_lshl_b32 s34, s30, 12
    v_add_u32 v16, s34, v16
    v_xor_b32 v17, 64, v16
    v_add_u32 v18, 65536, v16
    v_add_u32 v19, 65536, v17
    v_bfe_u32 v10, v1, 2, 2
    v_lshl_add_u32 v12, v11, 3, v10
    v_lshlrev_b32 v12, 7, v12
    v_lshrrev_b32 v13, 1, v10
    v_and_b32 v14, 1, v11
    v_lshl_or_b32 v13, v14, 1, v13
    s_lshl_b32 s34, s31, 1
    v_xor_b32 v13, s34, v13
    v_and_b32 v14, 3, v1
    v_lshl_add_u32 v12, v14, 3, v12
    v_add_u32 v12, 8192, v12
    v_lshl_add_u32 v20, v13, 5, v12
    v_xor_b32 v13, 1, v13
    v_lshl_add_u32 v21, v13, 5, v12
    v_add_u32 v22, 65536, v20
    v_add_u32 v23, 65536, v21

    s_lshl_b32 s34, s27, 6
    s_lshl_b32 s35, s30, 5
    s_add_u32 s34, s34, s35
    v_and_b32 v2, 15, v1
    v_add_u32 v2, s34, v2
    v_lshlrev_b32 v2, 10, v2
    v_lshrrev_b32 v10, 4, v1
    v_lshlrev_b32 v10, 3, v10
    s_lshl_b32 s35, s28, 7
    s_lshl_b32 s38, s31, 6
    s_add_u32 s35, s35, s38
    v_add_u32 v13, s35, v10
    v_add_u32 v9, v2, v13
    v_add_u32 v12, 0x4000, v9

    s_waitcnt lgkmcnt(0)
    s_add_u32 s96, s24, 0x400000
    s_addc_u32 s97, s25, 0
    s_mov_b32 s12, s20
    s_mov_b32 s13, s21
    s_cmp_eq_u32 s98, 0
    s_cselect_b32 s12, s12, s96
    s_cselect_b32 s13, s13, s97
    s_mov_b32 s14, 0x200000
    s_mov_b32 s15, 0x00020000
    s_add_u32 s16, s24, 0x200000
    s_addc_u32 s17, s25, 0
    s_mov_b32 s18, 0x200000
    s_mov_b32 s19, 0x00020000
    s_add_u32 s40, s24, 0x600000
    s_addc_u32 s41, s25, 0
    s_mov_b32 s42, 0x8000
    s_mov_b32 s43, 0x00020000
    s_mov_b32 s44, s36
    s_mov_b32 s45, s37
    s_mov_b32 s46, 0x400
    s_mov_b32 s47, 0x00020000
    buffer_load_dwordx2 v[48:49], v9, s[12:15], 0 offen offset:0
    buffer_load_dwordx2 v[50:51], v9, s[12:15], 0 offen offset:32
    buffer_load_dwordx2 v[52:53], v12, s[12:15], 0 offen offset:0
    buffer_load_dwordx2 v[54:55], v12, s[12:15], 0 offen offset:32
    buffer_load_dwordx2 v[56:57], v13, s[44:47], 0 offen offset:0
    buffer_load_dwordx2 v[58:59], v13, s[44:47], 0 offen offset:32
    s_barrier
    ds_read_b64_tr_b16 v[104:105], v20 offset:0
    ds_read_b64_tr_b16 v[106:107], v20 offset:512
    ds_read_b64_tr_b16 v[108:109], v21 offset:0
    ds_read_b64_tr_b16 v[110:111], v21 offset:512
    ds_read_b128 v[96:99], v16 offset:0
    ds_read_b128 v[100:103], v16 offset:2048
    s_waitcnt lgkmcnt(0)
    v_mfma_f32_16x16x32_bf16 v[32:35], v[104:107], v[96:99], 0
    ds_read_b64_tr_b16 v[120:121], v20 offset:4096
    ds_read_b64_tr_b16 v[122:123], v20 offset:4608
    v_mfma_f32_16x16x32_bf16 v[36:39], v[108:111], v[96:99], 0
    ds_read_b64_tr_b16 v[124:125], v21 offset:4096
    ds_read_b64_tr_b16 v[126:127], v21 offset:4608
    v_mfma_f32_16x16x32_bf16 v[40:43], v[104:107], v[100:103], 0
    ds_read_b128 v[112:115], v17 offset:0
    ds_read_b128 v[116:119], v17 offset:2048
    v_mfma_f32_16x16x32_bf16 v[44:47], v[108:111], v[100:103], 0
    s_waitcnt lgkmcnt(0)
    v_mfma_f32_16x16x32_bf16 v[32:35], v[120:123], v[112:115], v[32:35]
    ds_read_b64_tr_b16 v[104:105], v20 offset:16384
    ds_read_b64_tr_b16 v[106:107], v20 offset:16896
    v_mfma_f32_16x16x32_bf16 v[36:39], v[124:127], v[112:115], v[36:39]
    ds_read_b64_tr_b16 v[108:109], v21 offset:16384
    ds_read_b64_tr_b16 v[110:111], v21 offset:16896
    v_mfma_f32_16x16x32_bf16 v[40:43], v[120:123], v[116:119], v[40:43]
    ds_read_b128 v[96:99], v16 offset:16384
    ds_read_b128 v[100:103], v16 offset:18432
    v_mfma_f32_16x16x32_bf16 v[44:47], v[124:127], v[116:119], v[44:47]
    s_waitcnt lgkmcnt(0)
    v_mfma_f32_16x16x32_bf16 v[32:35], v[104:107], v[96:99], v[32:35]
    ds_read_b64_tr_b16 v[120:121], v20 offset:20480
    ds_read_b64_tr_b16 v[122:123], v20 offset:20992
    v_mfma_f32_16x16x32_bf16 v[36:39], v[108:111], v[96:99], v[36:39]
    ds_read_b64_tr_b16 v[124:125], v21 offset:20480
    ds_read_b64_tr_b16 v[126:127], v21 offset:20992
    v_mfma_f32_16x16x32_bf16 v[40:43], v[104:107], v[100:103], v[40:43]
    ds_read_b128 v[112:115], v17 offset:16384
    ds_read_b128 v[116:119], v17 offset:18432
    v_mfma_f32_16x16x32_bf16 v[44:47], v[108:111], v[100:103], v[44:47]
    s_waitcnt lgkmcnt(0)
    v_mfma_f32_16x16x32_bf16 v[32:35], v[120:123], v[112:115], v[32:35]
    v_mfma_f32_16x16x32_bf16 v[36:39], v[124:127], v[112:115], v[36:39]
    v_mfma_f32_16x16x32_bf16 v[40:43], v[120:123], v[116:119], v[40:43]
    v_mfma_f32_16x16x32_bf16 v[44:47], v[124:127], v[116:119], v[44:47]
    s_barrier
    ds_read_b64_tr_b16 v[104:105], v20 offset:32768
    ds_read_b64_tr_b16 v[106:107], v20 offset:33280
    ds_read_b64_tr_b16 v[108:109], v21 offset:32768
    ds_read_b64_tr_b16 v[110:111], v21 offset:33280
    ds_read_b128 v[96:99], v16 offset:32768
    ds_read_b128 v[100:103], v16 offset:34816
    s_waitcnt lgkmcnt(0)
    v_mfma_f32_16x16x32_bf16 v[32:35], v[104:107], v[96:99], v[32:35]
    ds_read_b64_tr_b16 v[120:121], v20 offset:36864
    ds_read_b64_tr_b16 v[122:123], v20 offset:37376
    v_mfma_f32_16x16x32_bf16 v[36:39], v[108:111], v[96:99], v[36:39]
    ds_read_b64_tr_b16 v[124:125], v21 offset:36864
    ds_read_b64_tr_b16 v[126:127], v21 offset:37376
    v_mfma_f32_16x16x32_bf16 v[40:43], v[104:107], v[100:103], v[40:43]
    ds_read_b128 v[112:115], v17 offset:32768
    ds_read_b128 v[116:119], v17 offset:34816
    v_mfma_f32_16x16x32_bf16 v[44:47], v[108:111], v[100:103], v[44:47]
    s_waitcnt lgkmcnt(0)
    v_mfma_f32_16x16x32_bf16 v[32:35], v[120:123], v[112:115], v[32:35]
    ds_read_b64_tr_b16 v[104:105], v20 offset:49152
    ds_read_b64_tr_b16 v[106:107], v20 offset:49664
    v_mfma_f32_16x16x32_bf16 v[36:39], v[124:127], v[112:115], v[36:39]
    ds_read_b64_tr_b16 v[108:109], v21 offset:49152
    ds_read_b64_tr_b16 v[110:111], v21 offset:49664
    v_mfma_f32_16x16x32_bf16 v[40:43], v[120:123], v[116:119], v[40:43]
    ds_read_b128 v[96:99], v16 offset:49152
    ds_read_b128 v[100:103], v16 offset:51200
    v_mfma_f32_16x16x32_bf16 v[44:47], v[124:127], v[116:119], v[44:47]
    s_waitcnt lgkmcnt(0)
    v_mfma_f32_16x16x32_bf16 v[32:35], v[104:107], v[96:99], v[32:35]
    ds_read_b64_tr_b16 v[120:121], v20 offset:53248
    ds_read_b64_tr_b16 v[122:123], v20 offset:53760
    v_mfma_f32_16x16x32_bf16 v[36:39], v[108:111], v[96:99], v[36:39]
    ds_read_b64_tr_b16 v[124:125], v21 offset:53248
    ds_read_b64_tr_b16 v[126:127], v21 offset:53760
    v_mfma_f32_16x16x32_bf16 v[40:43], v[104:107], v[100:103], v[40:43]
    ds_read_b128 v[112:115], v17 offset:49152
    ds_read_b128 v[116:119], v17 offset:51200
    v_mfma_f32_16x16x32_bf16 v[44:47], v[108:111], v[100:103], v[44:47]
    s_waitcnt lgkmcnt(0)
    v_mfma_f32_16x16x32_bf16 v[32:35], v[120:123], v[112:115], v[32:35]
    v_mfma_f32_16x16x32_bf16 v[36:39], v[124:127], v[112:115], v[36:39]
    v_mfma_f32_16x16x32_bf16 v[40:43], v[120:123], v[116:119], v[40:43]
    v_mfma_f32_16x16x32_bf16 v[44:47], v[124:127], v[116:119], v[44:47]
    s_barrier
    ds_read_b64_tr_b16 v[104:105], v22 offset:0
    ds_read_b64_tr_b16 v[106:107], v22 offset:512
    ds_read_b64_tr_b16 v[108:109], v23 offset:0
    ds_read_b64_tr_b16 v[110:111], v23 offset:512
    ds_read_b128 v[96:99], v18 offset:0
    ds_read_b128 v[100:103], v18 offset:2048
    s_waitcnt lgkmcnt(0)
    v_mfma_f32_16x16x32_bf16 v[32:35], v[104:107], v[96:99], v[32:35]
    ds_read_b64_tr_b16 v[120:121], v22 offset:4096
    ds_read_b64_tr_b16 v[122:123], v22 offset:4608
    v_mfma_f32_16x16x32_bf16 v[36:39], v[108:111], v[96:99], v[36:39]
    ds_read_b64_tr_b16 v[124:125], v23 offset:4096
    ds_read_b64_tr_b16 v[126:127], v23 offset:4608
    v_mfma_f32_16x16x32_bf16 v[40:43], v[104:107], v[100:103], v[40:43]
    ds_read_b128 v[112:115], v19 offset:0
    ds_read_b128 v[116:119], v19 offset:2048
    v_mfma_f32_16x16x32_bf16 v[44:47], v[108:111], v[100:103], v[44:47]
    s_waitcnt lgkmcnt(0)
    v_mfma_f32_16x16x32_bf16 v[32:35], v[120:123], v[112:115], v[32:35]
    ds_read_b64_tr_b16 v[104:105], v22 offset:16384
    ds_read_b64_tr_b16 v[106:107], v22 offset:16896
    v_mfma_f32_16x16x32_bf16 v[36:39], v[124:127], v[112:115], v[36:39]
    ds_read_b64_tr_b16 v[108:109], v23 offset:16384
    ds_read_b64_tr_b16 v[110:111], v23 offset:16896
    v_mfma_f32_16x16x32_bf16 v[40:43], v[120:123], v[116:119], v[40:43]
    ds_read_b128 v[96:99], v18 offset:16384
    ds_read_b128 v[100:103], v18 offset:18432
    v_mfma_f32_16x16x32_bf16 v[44:47], v[124:127], v[116:119], v[44:47]
    s_waitcnt lgkmcnt(0)
    v_mfma_f32_16x16x32_bf16 v[32:35], v[104:107], v[96:99], v[32:35]
    ds_read_b64_tr_b16 v[120:121], v22 offset:20480
    ds_read_b64_tr_b16 v[122:123], v22 offset:20992
    v_mfma_f32_16x16x32_bf16 v[36:39], v[108:111], v[96:99], v[36:39]
    ds_read_b64_tr_b16 v[124:125], v23 offset:20480
    ds_read_b64_tr_b16 v[126:127], v23 offset:20992
    v_mfma_f32_16x16x32_bf16 v[40:43], v[104:107], v[100:103], v[40:43]
    ds_read_b128 v[112:115], v19 offset:16384
    ds_read_b128 v[116:119], v19 offset:18432
    v_mfma_f32_16x16x32_bf16 v[44:47], v[108:111], v[100:103], v[44:47]
    s_waitcnt lgkmcnt(0)
    v_mfma_f32_16x16x32_bf16 v[32:35], v[120:123], v[112:115], v[32:35]
    v_mfma_f32_16x16x32_bf16 v[36:39], v[124:127], v[112:115], v[36:39]
    v_mfma_f32_16x16x32_bf16 v[40:43], v[120:123], v[116:119], v[40:43]
    v_mfma_f32_16x16x32_bf16 v[44:47], v[124:127], v[116:119], v[44:47]
    s_barrier
    ds_read_b64_tr_b16 v[104:105], v22 offset:32768
    ds_read_b64_tr_b16 v[106:107], v22 offset:33280
    ds_read_b64_tr_b16 v[108:109], v23 offset:32768
    ds_read_b64_tr_b16 v[110:111], v23 offset:33280
    ds_read_b128 v[96:99], v18 offset:32768
    ds_read_b128 v[100:103], v18 offset:34816
    s_waitcnt lgkmcnt(0)
    v_mfma_f32_16x16x32_bf16 v[32:35], v[104:107], v[96:99], v[32:35]
    ds_read_b64_tr_b16 v[120:121], v22 offset:36864
    ds_read_b64_tr_b16 v[122:123], v22 offset:37376
    v_mfma_f32_16x16x32_bf16 v[36:39], v[108:111], v[96:99], v[36:39]
    ds_read_b64_tr_b16 v[124:125], v23 offset:36864
    ds_read_b64_tr_b16 v[126:127], v23 offset:37376
    v_mfma_f32_16x16x32_bf16 v[40:43], v[104:107], v[100:103], v[40:43]
    ds_read_b128 v[112:115], v19 offset:32768
    ds_read_b128 v[116:119], v19 offset:34816
    v_mfma_f32_16x16x32_bf16 v[44:47], v[108:111], v[100:103], v[44:47]
    s_waitcnt lgkmcnt(0)
    v_mfma_f32_16x16x32_bf16 v[32:35], v[120:123], v[112:115], v[32:35]
    ds_read_b64_tr_b16 v[104:105], v22 offset:49152
    ds_read_b64_tr_b16 v[106:107], v22 offset:49664
    v_mfma_f32_16x16x32_bf16 v[36:39], v[124:127], v[112:115], v[36:39]
    ds_read_b64_tr_b16 v[108:109], v23 offset:49152
    ds_read_b64_tr_b16 v[110:111], v23 offset:49664
    v_mfma_f32_16x16x32_bf16 v[40:43], v[120:123], v[116:119], v[40:43]
    ds_read_b128 v[96:99], v18 offset:49152
    ds_read_b128 v[100:103], v18 offset:51200
    v_mfma_f32_16x16x32_bf16 v[44:47], v[124:127], v[116:119], v[44:47]
    s_waitcnt lgkmcnt(0)
    v_mfma_f32_16x16x32_bf16 v[32:35], v[104:107], v[96:99], v[32:35]
    ds_read_b64_tr_b16 v[120:121], v22 offset:53248
    ds_read_b64_tr_b16 v[122:123], v22 offset:53760
    v_mfma_f32_16x16x32_bf16 v[36:39], v[108:111], v[96:99], v[36:39]
    ds_read_b64_tr_b16 v[124:125], v23 offset:53248
    ds_read_b64_tr_b16 v[126:127], v23 offset:53760
    v_mfma_f32_16x16x32_bf16 v[40:43], v[104:107], v[100:103], v[40:43]
    ds_read_b128 v[112:115], v19 offset:49152
    ds_read_b128 v[116:119], v19 offset:51200
    v_mfma_f32_16x16x32_bf16 v[44:47], v[108:111], v[100:103], v[44:47]
    s_waitcnt lgkmcnt(0)
    v_mfma_f32_16x16x32_bf16 v[32:35], v[120:123], v[112:115], v[32:35]
    v_mfma_f32_16x16x32_bf16 v[36:39], v[124:127], v[112:115], v[36:39]
    v_mfma_f32_16x16x32_bf16 v[40:43], v[120:123], v[116:119], v[40:43]
    v_mfma_f32_16x16x32_bf16 v[44:47], v[124:127], v[116:119], v[44:47]
    s_waitcnt vmcnt(0)
    s_nop 7
    v_lshlrev_b32 v64, 16, v56
    v_and_b32 v65, 0xffff0000, v56
    v_lshlrev_b32 v66, 16, v57
    v_and_b32 v67, 0xffff0000, v57
    v_lshlrev_b32 v68, 16, v58
    v_and_b32 v69, 0xffff0000, v58
    v_lshlrev_b32 v70, 16, v59
    v_and_b32 v71, 0xffff0000, v59
    v_cvt_pk_bf16_f32 v72, v32, v33
    v_lshlrev_b32 v73, 16, v72
    v_and_b32 v74, 0xffff0000, v72
    v_lshlrev_b32 v75, 16, v48
    v_and_b32 v76, 0xffff0000, v48
    v_add_f32 v73, v73, v75
    v_add_f32 v74, v74, v76
    v_cvt_pk_bf16_f32 v48, v73, v74
    v_lshlrev_b32 v73, 16, v48
    v_and_b32 v74, 0xffff0000, v48
    v_add_f32 v80, v73, v74
    v_mul_f32 v81, v73, v73
    v_mul_f32 v82, v73, v64
    v_fma_f32 v81, v74, v74, v81
    v_fma_f32 v82, v74, v65, v82
    v_cvt_pk_bf16_f32 v72, v34, v35
    v_lshlrev_b32 v73, 16, v72
    v_and_b32 v74, 0xffff0000, v72
    v_lshlrev_b32 v75, 16, v49
    v_and_b32 v76, 0xffff0000, v49
    v_add_f32 v73, v73, v75
    v_add_f32 v74, v74, v76
    v_cvt_pk_bf16_f32 v49, v73, v74
    v_lshlrev_b32 v73, 16, v49
    v_and_b32 v74, 0xffff0000, v49
    v_add_f32 v80, v80, v73
    v_add_f32 v80, v80, v74
    v_fma_f32 v81, v73, v73, v81
    v_fma_f32 v82, v73, v66, v82
    v_fma_f32 v81, v74, v74, v81
    v_fma_f32 v82, v74, v67, v82
    buffer_store_dwordx2 v[48:49], v9, s[16:19], 0 offen offset:0
    v_cvt_pk_bf16_f32 v72, v36, v37
    v_lshlrev_b32 v73, 16, v72
    v_and_b32 v74, 0xffff0000, v72
    v_lshlrev_b32 v75, 16, v50
    v_and_b32 v76, 0xffff0000, v50
    v_add_f32 v73, v73, v75
    v_add_f32 v74, v74, v76
    v_cvt_pk_bf16_f32 v50, v73, v74
    v_lshlrev_b32 v73, 16, v50
    v_and_b32 v74, 0xffff0000, v50
    v_add_f32 v80, v80, v73
    v_add_f32 v80, v80, v74
    v_fma_f32 v81, v73, v73, v81
    v_fma_f32 v82, v73, v68, v82
    v_fma_f32 v81, v74, v74, v81
    v_fma_f32 v82, v74, v69, v82
    v_cvt_pk_bf16_f32 v72, v38, v39
    v_lshlrev_b32 v73, 16, v72
    v_and_b32 v74, 0xffff0000, v72
    v_lshlrev_b32 v75, 16, v51
    v_and_b32 v76, 0xffff0000, v51
    v_add_f32 v73, v73, v75
    v_add_f32 v74, v74, v76
    v_cvt_pk_bf16_f32 v51, v73, v74
    v_lshlrev_b32 v73, 16, v51
    v_and_b32 v74, 0xffff0000, v51
    v_add_f32 v80, v80, v73
    v_add_f32 v80, v80, v74
    v_fma_f32 v81, v73, v73, v81
    v_fma_f32 v82, v73, v70, v82
    v_fma_f32 v81, v74, v74, v81
    v_fma_f32 v82, v74, v71, v82
    buffer_store_dwordx2 v[50:51], v9, s[16:19], 0 offen offset:32
    v_cvt_pk_bf16_f32 v72, v40, v41
    v_lshlrev_b32 v73, 16, v72
    v_and_b32 v74, 0xffff0000, v72
    v_lshlrev_b32 v75, 16, v52
    v_and_b32 v76, 0xffff0000, v52
    v_add_f32 v73, v73, v75
    v_add_f32 v74, v74, v76
    v_cvt_pk_bf16_f32 v52, v73, v74
    v_lshlrev_b32 v73, 16, v52
    v_and_b32 v74, 0xffff0000, v52
    v_add_f32 v84, v73, v74
    v_mul_f32 v85, v73, v73
    v_mul_f32 v86, v73, v64
    v_fma_f32 v85, v74, v74, v85
    v_fma_f32 v86, v74, v65, v86
    v_cvt_pk_bf16_f32 v72, v42, v43
    v_lshlrev_b32 v73, 16, v72
    v_and_b32 v74, 0xffff0000, v72
    v_lshlrev_b32 v75, 16, v53
    v_and_b32 v76, 0xffff0000, v53
    v_add_f32 v73, v73, v75
    v_add_f32 v74, v74, v76
    v_cvt_pk_bf16_f32 v53, v73, v74
    v_lshlrev_b32 v73, 16, v53
    v_and_b32 v74, 0xffff0000, v53
    v_add_f32 v84, v84, v73
    v_add_f32 v84, v84, v74
    v_fma_f32 v85, v73, v73, v85
    v_fma_f32 v86, v73, v66, v86
    v_fma_f32 v85, v74, v74, v85
    v_fma_f32 v86, v74, v67, v86
    buffer_store_dwordx2 v[52:53], v12, s[16:19], 0 offen offset:0
    v_cvt_pk_bf16_f32 v72, v44, v45
    v_lshlrev_b32 v73, 16, v72
    v_and_b32 v74, 0xffff0000, v72
    v_lshlrev_b32 v75, 16, v54
    v_and_b32 v76, 0xffff0000, v54
    v_add_f32 v73, v73, v75
    v_add_f32 v74, v74, v76
    v_cvt_pk_bf16_f32 v54, v73, v74
    v_lshlrev_b32 v73, 16, v54
    v_and_b32 v74, 0xffff0000, v54
    v_add_f32 v84, v84, v73
    v_add_f32 v84, v84, v74
    v_fma_f32 v85, v73, v73, v85
    v_fma_f32 v86, v73, v68, v86
    v_fma_f32 v85, v74, v74, v85
    v_fma_f32 v86, v74, v69, v86
    v_cvt_pk_bf16_f32 v72, v46, v47
    v_lshlrev_b32 v73, 16, v72
    v_and_b32 v74, 0xffff0000, v72
    v_lshlrev_b32 v75, 16, v55
    v_and_b32 v76, 0xffff0000, v55
    v_add_f32 v73, v73, v75
    v_add_f32 v74, v74, v76
    v_cvt_pk_bf16_f32 v55, v73, v74
    v_lshlrev_b32 v73, 16, v55
    v_and_b32 v74, 0xffff0000, v55
    v_add_f32 v84, v84, v73
    v_add_f32 v84, v84, v74
    v_fma_f32 v85, v73, v73, v85
    v_fma_f32 v86, v73, v70, v86
    v_fma_f32 v85, v74, v74, v85
    v_fma_f32 v86, v74, v71, v86
    buffer_store_dwordx2 v[54:55], v12, s[16:19], 0 offen offset:32
    v_mov_b32 v88, v80
    v_mov_b32 v89, v81
    v_mov_b32 v90, v82
    v_mov_b32 v91, v84
    v_mov_b32 v92, v85
    v_mov_b32 v93, v86
    s_nop 1
    v_permlane16_swap_b32 v80, v88
    v_permlane16_swap_b32 v81, v89
    v_permlane16_swap_b32 v82, v90
    v_permlane16_swap_b32 v84, v91
    v_permlane16_swap_b32 v85, v92
    v_permlane16_swap_b32 v86, v93
    s_nop 0
    v_add_f32 v80, v80, v88
    v_add_f32 v81, v81, v89
    v_add_f32 v82, v82, v90
    v_add_f32 v84, v84, v91
    v_add_f32 v85, v85, v92
    v_add_f32 v86, v86, v93
    v_mov_b32 v88, v80
    v_mov_b32 v89, v81
    v_mov_b32 v90, v82
    v_mov_b32 v91, v84
    v_mov_b32 v92, v85
    v_mov_b32 v93, v86
    s_nop 1
    v_permlane32_swap_b32 v80, v88
    v_permlane32_swap_b32 v81, v89
    v_permlane32_swap_b32 v82, v90
    v_permlane32_swap_b32 v84, v91
    v_permlane32_swap_b32 v85, v92
    v_permlane32_swap_b32 v86, v93
    s_nop 0
    v_add_f32 v80, v80, v88
    v_add_f32 v81, v81, v89
    v_add_f32 v82, v82, v90
    v_add_f32 v84, v84, v91
    v_add_f32 v85, v85, v92
    v_add_f32 v86, v86, v93
    v_lshrrev_b32 v88, 4, v1
    v_cmp_eq_u32 s[48:49], 1, v88
    v_cmp_eq_u32 s[50:51], 2, v88
    v_cmp_eq_u32 s[52:53], 3, v88
    v_lshrrev_b32 v89, 8, v2
    v_lshl_add_u32 v89, v88, 13, v89
    v_add_u32 v90, 64, v89

    v_cndmask_b32 v80, v80, v81, s[48:49]
    v_cndmask_b32 v80, v80, v82, s[50:51]
    v_cndmask_b32 v84, v84, v85, s[48:49]
    v_cndmask_b32 v84, v84, v86, s[50:51]
    s_andn2_b64 exec, exec, s[52:53]
    buffer_atomic_add_f32 v80, v89, s[40:43], 0 offen
    buffer_atomic_add_f32 v84, v90, s[40:43], 0 offen
L_k2s_end:
    s_endpgm
.section .rodata,"a"
.p2align 6
.amdhsa_kernel k2l0_kernel
  .amdhsa_next_free_vgpr 128
  .amdhsa_next_free_sgpr 102
  .amdhsa_accum_offset 128
  .amdhsa_group_segment_fixed_size 0
  .amdhsa_kernarg_size 88
  .amdhsa_user_sgpr_count 2
  .amdhsa_user_sgpr_kernarg_segment_ptr 1
  .amdhsa_system_sgpr_workgroup_id_x 1
.end_amdhsa_kernel
.section .rodata,"a"
.p2align 6
.amdhsa_kernel k2l1_kernel
  .amdhsa_next_free_vgpr 128
  .amdhsa_next_free_sgpr 102
  .amdhsa_accum_offset 128
  .amdhsa_group_segment_fixed_size 0
  .amdhsa_kernarg_size 88
  .amdhsa_user_sgpr_count 2
  .amdhsa_user_sgpr_kernarg_segment_ptr 1
  .amdhsa_system_sgpr_workgroup_id_x 1
.end_amdhsa_kernel

.text
.globl k3l0_kernel
.p2align 8
.type k3l0_kernel,@function
k3l0_kernel:
    s_mov_b32 s98, 0
    s_branch L_k3s_body
.globl k3l1_kernel
.p2align 8
.type k3l1_kernel,@function
k3l1_kernel:
    s_mov_b32 s98, 1
L_k3s_body:
    s_cmp_ge_u32 s2, 256
    s_cbranch_scc1 L_k3s_end
    s_load_dwordx4 s[20:23], s[0:1], 32
    s_load_dwordx4 s[28:31], s[0:1], 48
    s_load_dwordx2 s[24:25], s[0:1], 80
    s_load_dwordx2 s[26:27], s[0:1], 64
    s_load_dwordx2 s[64:65], s[0:1], 72
    v_lshrrev_b32 v1, 6, v0
    s_nop 0
    v_readfirstlane_b32 s33, v1
    v_and_b32 v1, 63, v0
    s_lshl_b32 s32, s2, 7
    s_mov_b32 s56, 0x3b000000
    s_mov_b32 s57, 0x3727c5ac
    s_mov_b32 s58, 0x3f803f80
    s_cmp_lt_u32 s33, 4
    s_cbranch_scc1 L_k3s_mm

    s_sub_u32 s33, s33, 4
    v_and_b32 v0, 255, v0
    s_waitcnt lgkmcnt(0)
    s_add_u32 s4, s24, 0x600000
    s_addc_u32 s5, s25, 0
    s_mov_b32 s6, 0x8000
    s_mov_b32 s7, 0x00020000
    s_add_u32 s8, s24, 0x200000
    s_addc_u32 s9, s25, 0
    s_mov_b32 s10, 0x200000
    s_mov_b32 s11, 0x00020000
    s_mov_b32 s96, s26
    s_mov_b32 s97, s27
    s_add_u32 s12, s24, 0x400000
    s_addc_u32 s13, s25, 0
    s_cmp_eq_u32 s98, 0
    s_cselect_b32 s12, s12, s96
    s_cselect_b32 s13, s13, s97
    s_mov_b32 s14, 0x200000
    s_mov_b32 s15, 0x00020000
    s_mov_b32 s48, s64
    s_mov_b32 s49, s65
    s_mov_b32 s50, 0x100
    s_mov_b32 s51, 0x00020000
    s_and_b32 s35, s2, 7
    s_lshl_b32 s35, s35, 5
    s_lshr_b32 s34, s2, 3
    s_add_u32 s35, s35, s34
    s_lshl_b32 s34, s35, 13
    v_lshlrev_b32 v4, 4, v0
    v_add_u32 v4, s34, v4
    v_add_u32 v5, 4096, v4
    s_lshl_b32 s34, s35, 3
    s_add_u32 s34, s34, s33
    s_lshl_b32 s34, s34, 2
    v_mov_b32 v6, s34
    s_mov_b32 s34, 8192
    buffer_load_dword v8, v6, s[4:7], 0 offen
    buffer_load_dword v9, v6, s[4:7], s34 offen
    buffer_load_dword v12, v6, s[4:7], 0 offen offset:16
    buffer_load_dword v13, v6, s[4:7], s34 offen offset:16
    buffer_load_dwordx4 v[100:103], v4, s[8:11], 0 offen
    buffer_load_dwordx4 v[104:107], v5, s[8:11], 0 offen

    s_cmp_ge_u32 s2, 28
    s_cbranch_scc1 L_k3s_x2only
    s_barrier
    s_mov_b32 s36, s22
    s_mov_b32 s37, s23
    s_mov_b32 s38, 0x1c0000
    s_mov_b32 s39, 0x00020000
    s_mov_b32 s40, s28
    s_mov_b32 s41, s29
    s_mov_b32 s42, 0x1c0000
    s_mov_b32 s43, 0x00020000
    s_mov_b32 s44, s30
    s_mov_b32 s45, s31
    s_mov_b32 s46, 0x1c0000
    s_mov_b32 s47, 0x00020000
    v_lshrrev_b32 v20, 3, v1
    v_and_b32 v21, 7, v1
    s_lshl_b32 s35, s33, 7
    v_add_u32 v22, s35, v20
    v_mul_u32_u24 v22, 3584, v22
    v_add_u32 v22, s32, v22
    v_bfe_u32 v23, v20, 1, 1
    v_lshlrev_b32 v23, 1, v23
    v_xor_b32 v23, v23, v21
    v_lshl_add_u32 v2, v23, 4, v22
    v_xor_b32 v23, 4, v23
    v_lshl_add_u32 v3, v23, 4, v22
    s_lshl_b32 s52, s33, 14

    s_mov_b32 s34, 0
    s_add_u32 m0, s52, 0
    s_nop 0
    buffer_load_dwordx4 v2, s[36:39], s34 offen lds
    s_add_u32 m0, s52, 65536
    s_nop 0
    buffer_load_dwordx4 v2, s[40:43], s34 offen lds
    s_mov_b32 s34, 28672
    s_add_u32 m0, s52, 1024
    s_nop 0
    buffer_load_dwordx4 v3, s[36:39], s34 offen lds
    s_add_u32 m0, s52, 66560
    s_nop 0
    buffer_load_dwordx4 v3, s[40:43], s34 offen lds
    s_mov_b32 s34, 57344
    s_add_u32 m0, s52, 2048
    s_nop 0
    buffer_load_dwordx4 v2, s[36:39], s34 offen lds
    s_add_u32 m0, s52, 67584
    s_nop 0
    buffer_load_dwordx4 v2, s[40:43], s34 offen lds
    s_mov_b32 s34, 86016
    s_add_u32 m0, s52, 3072
    s_nop 0
    buffer_load_dwordx4 v3, s[36:39], s34 offen lds
    s_add_u32 m0, s52, 68608
    s_nop 0
    buffer_load_dwordx4 v3, s[40:43], s34 offen lds
    s_mov_b32 s34, 114688
    s_add_u32 m0, s52, 4096
    s_nop 0
    buffer_load_dwordx4 v2, s[36:39], s34 offen lds
    s_add_u32 m0, s52, 69632
    s_nop 0
    buffer_load_dwordx4 v2, s[40:43], s34 offen lds
    s_mov_b32 s34, 143360
    s_add_u32 m0, s52, 5120
    s_nop 0
    buffer_load_dwordx4 v3, s[36:39], s34 offen lds
    s_add_u32 m0, s52, 70656
    s_nop 0
    buffer_load_dwordx4 v3, s[40:43], s34 offen lds
    s_mov_b32 s34, 172032
    s_add_u32 m0, s52, 6144
    s_nop 0
    buffer_load_dwordx4 v2, s[36:39], s34 offen lds
    s_add_u32 m0, s52, 71680
    s_nop 0
    buffer_load_dwordx4 v2, s[40:43], s34 offen lds
    s_mov_b32 s34, 200704
    s_add_u32 m0, s52, 7168
    s_nop 0
    buffer_load_dwordx4 v3, s[36:39], s34 offen lds
    s_add_u32 m0, s52, 72704
    s_nop 0
    buffer_load_dwordx4 v3, s[40:43], s34 offen lds
    s_mov_b32 s34, 229376
    s_add_u32 m0, s52, 8192
    s_nop 0
    buffer_load_dwordx4 v2, s[36:39], s34 offen lds
    s_add_u32 m0, s52, 73728
    s_nop 0
    buffer_load_dwordx4 v2, s[40:43], s34 offen lds
    s_mov_b32 s34, 258048
    s_add_u32 m0, s52, 9216
    s_nop 0
    buffer_load_dwordx4 v3, s[36:39], s34 offen lds
    s_add_u32 m0, s52, 74752
    s_nop 0
    buffer_load_dwordx4 v3, s[40:43], s34 offen lds
    s_mov_b32 s34, 286720
    s_add_u32 m0, s52, 10240
    s_nop 0
    buffer_load_dwordx4 v2, s[36:39], s34 offen lds
    s_add_u32 m0, s52, 75776
    s_nop 0
    buffer_load_dwordx4 v2, s[40:43], s34 offen lds
    s_mov_b32 s34, 315392
    s_add_u32 m0, s52, 11264
    s_nop 0
    buffer_load_dwordx4 v3, s[36:39], s34 offen lds
    s_add_u32 m0, s52, 76800
    s_nop 0
    buffer_load_dwordx4 v3, s[40:43], s34 offen lds
    s_mov_b32 s34, 344064
    s_add_u32 m0, s52, 12288
    s_nop 0
    buffer_load_dwordx4 v2, s[36:39], s34 offen lds
    s_add_u32 m0, s52, 77824
    s_nop 0
    buffer_load_dwordx4 v2, s[40:43], s34 offen lds
    s_mov_b32 s34, 372736
    s_add_u32 m0, s52, 13312
    s_nop 0
    buffer_load_dwordx4 v3, s[36:39], s34 offen lds
    s_add_u32 m0, s52, 78848
    s_nop 0
    buffer_load_dwordx4 v3, s[40:43], s34 offen lds
    s_mov_b32 s34, 401408
    s_add_u32 m0, s52, 14336
    s_nop 0
    buffer_load_dwordx4 v2, s[36:39], s34 offen lds
    s_add_u32 m0, s52, 79872
    s_nop 0
    buffer_load_dwordx4 v2, s[40:43], s34 offen lds
    s_mov_b32 s34, 430080
    s_add_u32 m0, s52, 15360
    s_nop 0
    buffer_load_dwordx4 v3, s[36:39], s34 offen lds
    s_add_u32 m0, s52, 80896
    s_nop 0
    buffer_load_dwordx4 v3, s[40:43], s34 offen lds
    s_lshl_b32 s34, s2, 16
    s_lshl_b32 s35, s33, 14
    s_add_u32 s34, s34, s35
    v_lshlrev_b32 v7, 4, v1
    v_add_u32 v7, s34, v7

    s_mov_b32 s34, 0
    buffer_load_dwordx4 v[112:115], v7, s[44:47], s34 offen
    s_mov_b32 s34, 1024
    buffer_load_dwordx4 v[116:119], v7, s[44:47], s34 offen
    s_mov_b32 s34, 2048
    buffer_load_dwordx4 v[120:123], v7, s[44:47], s34 offen
    s_mov_b32 s34, 3072
    buffer_load_dwordx4 v[124:127], v7, s[44:47], s34 offen
    s_mov_b32 s34, 4096
    buffer_load_dwordx4 v[128:131], v7, s[44:47], s34 offen
    s_mov_b32 s34, 5120
    buffer_load_dwordx4 v[132:135], v7, s[44:47], s34 offen
    s_mov_b32 s34, 6144
    buffer_load_dwordx4 v[136:139], v7, s[44:47], s34 offen
    s_mov_b32 s34, 7168
    buffer_load_dwordx4 v[140:143], v7, s[44:47], s34 offen
    s_mov_b32 s34, 8192
    buffer_load_dwordx4 v[144:147], v7, s[44:47], s34 offen
    s_mov_b32 s34, 9216
    buffer_load_dwordx4 v[148:151], v7, s[44:47], s34 offen
    s_mov_b32 s34, 10240
    buffer_load_dwordx4 v[152:155], v7, s[44:47], s34 offen
    s_mov_b32 s34, 11264
    buffer_load_dwordx4 v[156:159], v7, s[44:47], s34 offen
    s_mov_b32 s34, 12288
    buffer_load_dwordx4 v[160:163], v7, s[44:47], s34 offen
    s_mov_b32 s34, 13312
    buffer_load_dwordx4 v[164:167], v7, s[44:47], s34 offen
    s_mov_b32 s34, 14336
    buffer_load_dwordx4 v[168:171], v7, s[44:47], s34 offen
    s_mov_b32 s34, 15360
    buffer_load_dwordx4 v[172:175], v7, s[44:47], s34 offen
    s_branch L_k3s_ffnl
L_k3s_x2only:
    s_waitcnt vmcnt(0)
    v_mul_f32 v40, s56, v8
    v_mul_f32 v42, s56, v9
    v_fma_f32 v42, -v40, v40, v42
    v_max_f32 v42, 0, v42
    v_cvt_pk_bf16_f32 v40, v40, v40
    v_lshlrev_b32 v40, 16, v40
    v_cvt_pk_bf16_f32 v42, v42, v42
    v_lshlrev_b32 v42, 16, v42
    v_add_f32 v42, s57, v42
    v_cvt_pk_bf16_f32 v42, v42, v42
    v_lshlrev_b32 v42, 16, v42
    v_sqrt_f32 v42, v42
    s_nop 0
    v_cvt_pk_bf16_f32 v42, v42, v42
    v_lshlrev_b32 v42, 16, v42
    v_rcp_f32 v41, v42
    s_nop 0
    v_mul_f32 v43, s56, v12
    v_mul_f32 v45, s56, v13
    v_fma_f32 v45, -v43, v43, v45
    v_max_f32 v45, 0, v45
    v_cvt_pk_bf16_f32 v43, v43, v43
    v_lshlrev_b32 v43, 16, v43
    v_cvt_pk_bf16_f32 v45, v45, v45
    v_lshlrev_b32 v45, 16, v45
    v_add_f32 v45, s57, v45
    v_cvt_pk_bf16_f32 v45, v45, v45
    v_lshlrev_b32 v45, 16, v45
    v_sqrt_f32 v45, v45
    s_nop 0
    v_cvt_pk_bf16_f32 v45, v45, v45
    v_lshlrev_b32 v45, 16, v45
    v_rcp_f32 v44, v45
    s_nop 0
    v_lshlrev_b32 v50, 16, v100
    v_and_b32 v51, 0xffff0000, v100
    v_sub_f32 v52, v50, v40
    v_sub_f32 v53, v51, v40
    v_cvt_pk_bf16_f32 v54, v52, v53
    v_lshlrev_b32 v52, 16, v54
    v_and_b32 v53, 0xffff0000, v54
    v_mul_f32 v52, v52, v41
    v_mul_f32 v53, v53, v41
    v_cvt_pk_bf16_f32 v54, v52, v53
    v_lshlrev_b32 v52, 16, v54
    v_and_b32 v53, 0xffff0000, v54
    v_add_f32 v52, v52, v50
    v_add_f32 v53, v53, v51
    v_cvt_pk_bf16_f32 v100, v52, v53
    v_lshlrev_b32 v50, 16, v101
    v_and_b32 v51, 0xffff0000, v101
    v_sub_f32 v52, v50, v40
    v_sub_f32 v53, v51, v40
    v_cvt_pk_bf16_f32 v54, v52, v53
    v_lshlrev_b32 v52, 16, v54
    v_and_b32 v53, 0xffff0000, v54
    v_mul_f32 v52, v52, v41
    v_mul_f32 v53, v53, v41
    v_cvt_pk_bf16_f32 v54, v52, v53
    v_lshlrev_b32 v52, 16, v54
    v_and_b32 v53, 0xffff0000, v54
    v_add_f32 v52, v52, v50
    v_add_f32 v53, v53, v51
    v_cvt_pk_bf16_f32 v101, v52, v53
    v_lshlrev_b32 v50, 16, v102
    v_and_b32 v51, 0xffff0000, v102
    v_sub_f32 v52, v50, v40
    v_sub_f32 v53, v51, v40
    v_cvt_pk_bf16_f32 v54, v52, v53
    v_lshlrev_b32 v52, 16, v54
    v_and_b32 v53, 0xffff0000, v54
    v_mul_f32 v52, v52, v41
    v_mul_f32 v53, v53, v41
    v_cvt_pk_bf16_f32 v54, v52, v53
    v_lshlrev_b32 v52, 16, v54
    v_and_b32 v53, 0xffff0000, v54
    v_add_f32 v52, v52, v50
    v_add_f32 v53, v53, v51
    v_cvt_pk_bf16_f32 v102, v52, v53
    v_lshlrev_b32 v50, 16, v103
    v_and_b32 v51, 0xffff0000, v103
    v_sub_f32 v52, v50, v40
    v_sub_f32 v53, v51, v40
    v_cvt_pk_bf16_f32 v54, v52, v53
    v_lshlrev_b32 v52, 16, v54
    v_and_b32 v53, 0xffff0000, v54
    v_mul_f32 v52, v52, v41
    v_mul_f32 v53, v53, v41
    v_cvt_pk_bf16_f32 v54, v52, v53
    v_lshlrev_b32 v52, 16, v54
    v_and_b32 v53, 0xffff0000, v54
    v_add_f32 v52, v52, v50
    v_add_f32 v53, v53, v51
    v_cvt_pk_bf16_f32 v103, v52, v53
    buffer_store_dwordx4 v[100:103], v4, s[12:15], 0 offen
    v_lshlrev_b32 v50, 16, v104
    v_and_b32 v51, 0xffff0000, v104
    v_sub_f32 v52, v50, v43
    v_sub_f32 v53, v51, v43
    v_cvt_pk_bf16_f32 v54, v52, v53
    v_lshlrev_b32 v52, 16, v54
    v_and_b32 v53, 0xffff0000, v54
    v_mul_f32 v52, v52, v44
    v_mul_f32 v53, v53, v44
    v_cvt_pk_bf16_f32 v54, v52, v53
    v_lshlrev_b32 v52, 16, v54
    v_and_b32 v53, 0xffff0000, v54
    v_add_f32 v52, v52, v50
    v_add_f32 v53, v53, v51
    v_cvt_pk_bf16_f32 v104, v52, v53
    v_lshlrev_b32 v50, 16, v105
    v_and_b32 v51, 0xffff0000, v105
    v_sub_f32 v52, v50, v43
    v_sub_f32 v53, v51, v43
    v_cvt_pk_bf16_f32 v54, v52, v53
    v_lshlrev_b32 v52, 16, v54
    v_and_b32 v53, 0xffff0000, v54
    v_mul_f32 v52, v52, v44
    v_mul_f32 v53, v53, v44
    v_cvt_pk_bf16_f32 v54, v52, v53
    v_lshlrev_b32 v52, 16, v54
    v_and_b32 v53, 0xffff0000, v54
    v_add_f32 v52, v52, v50
    v_add_f32 v53, v53, v51
    v_cvt_pk_bf16_f32 v105, v52, v53
    v_lshlrev_b32 v50, 16, v106
    v_and_b32 v51, 0xffff0000, v106
    v_sub_f32 v52, v50, v43
    v_sub_f32 v53, v51, v43
    v_cvt_pk_bf16_f32 v54, v52, v53
    v_lshlrev_b32 v52, 16, v54
    v_and_b32 v53, 0xffff0000, v54
    v_mul_f32 v52, v52, v44
    v_mul_f32 v53, v53, v44
    v_cvt_pk_bf16_f32 v54, v52, v53
    v_lshlrev_b32 v52, 16, v54
    v_and_b32 v53, 0xffff0000, v54
    v_add_f32 v52, v52, v50
    v_add_f32 v53, v53, v51
    v_cvt_pk_bf16_f32 v106, v52, v53
    v_lshlrev_b32 v50, 16, v107
    v_and_b32 v51, 0xffff0000, v107
    v_sub_f32 v52, v50, v43
    v_sub_f32 v53, v51, v43
    v_cvt_pk_bf16_f32 v54, v52, v53
    v_lshlrev_b32 v52, 16, v54
    v_and_b32 v53, 0xffff0000, v54
    v_mul_f32 v52, v52, v44
    v_mul_f32 v53, v53, v44
    v_cvt_pk_bf16_f32 v54, v52, v53
    v_lshlrev_b32 v52, 16, v54
    v_and_b32 v53, 0xffff0000, v54
    v_add_f32 v52, v52, v50
    v_add_f32 v53, v53, v51
    v_cvt_pk_bf16_f32 v107, v52, v53
    buffer_store_dwordx4 v[104:107], v5, s[12:15], 0 offen
    s_endpgm
L_k3s_ffnl:
    s_waitcnt vmcnt(16)
    s_barrier
    v_mul_f32 v40, s56, v8
    v_mul_f32 v42, s56, v9
    v_fma_f32 v42, -v40, v40, v42
    v_max_f32 v42, 0, v42
    v_cvt_pk_bf16_f32 v40, v40, v40
    v_lshlrev_b32 v40, 16, v40
    v_cvt_pk_bf16_f32 v42, v42, v42
    v_lshlrev_b32 v42, 16, v42
    v_add_f32 v42, s57, v42
    v_cvt_pk_bf16_f32 v42, v42, v42
    v_lshlrev_b32 v42, 16, v42
    v_sqrt_f32 v42, v42
    s_nop 0
    v_cvt_pk_bf16_f32 v42, v42, v42
    v_lshlrev_b32 v42, 16, v42
    v_rcp_f32 v41, v42
    s_nop 0
    v_mul_f32 v43, s56, v12
    v_mul_f32 v45, s56, v13
    v_fma_f32 v45, -v43, v43, v45
    v_max_f32 v45, 0, v45
    v_cvt_pk_bf16_f32 v43, v43, v43
    v_lshlrev_b32 v43, 16, v43
    v_cvt_pk_bf16_f32 v45, v45, v45
    v_lshlrev_b32 v45, 16, v45
    v_add_f32 v45, s57, v45
    v_cvt_pk_bf16_f32 v45, v45, v45
    v_lshlrev_b32 v45, 16, v45
    v_sqrt_f32 v45, v45
    s_nop 0
    v_cvt_pk_bf16_f32 v45, v45, v45
    v_lshlrev_b32 v45, 16, v45
    v_rcp_f32 v44, v45
    s_nop 0
    v_lshlrev_b32 v50, 16, v100
    v_and_b32 v51, 0xffff0000, v100
    v_sub_f32 v52, v50, v40
    v_sub_f32 v53, v51, v40
    v_cvt_pk_bf16_f32 v54, v52, v53
    v_lshlrev_b32 v52, 16, v54
    v_and_b32 v53, 0xffff0000, v54
    v_mul_f32 v52, v52, v41
    v_mul_f32 v53, v53, v41
    v_cvt_pk_bf16_f32 v54, v52, v53
    v_lshlrev_b32 v52, 16, v54
    v_and_b32 v53, 0xffff0000, v54
    v_add_f32 v52, v52, v50
    v_add_f32 v53, v53, v51
    v_cvt_pk_bf16_f32 v100, v52, v53
    v_lshlrev_b32 v50, 16, v101
    v_and_b32 v51, 0xffff0000, v101
    v_sub_f32 v52, v50, v40
    v_sub_f32 v53, v51, v40
    v_cvt_pk_bf16_f32 v54, v52, v53
    v_lshlrev_b32 v52, 16, v54
    v_and_b32 v53, 0xffff0000, v54
    v_mul_f32 v52, v52, v41
    v_mul_f32 v53, v53, v41
    v_cvt_pk_bf16_f32 v54, v52, v53
    v_lshlrev_b32 v52, 16, v54
    v_and_b32 v53, 0xffff0000, v54
    v_add_f32 v52, v52, v50
    v_add_f32 v53, v53, v51
    v_cvt_pk_bf16_f32 v101, v52, v53
    v_lshlrev_b32 v50, 16, v102
    v_and_b32 v51, 0xffff0000, v102
    v_sub_f32 v52, v50, v40
    v_sub_f32 v53, v51, v40
    v_cvt_pk_bf16_f32 v54, v52, v53
    v_lshlrev_b32 v52, 16, v54
    v_and_b32 v53, 0xffff0000, v54
    v_mul_f32 v52, v52, v41
    v_mul_f32 v53, v53, v41
    v_cvt_pk_bf16_f32 v54, v52, v53
    v_lshlrev_b32 v52, 16, v54
    v_and_b32 v53, 0xffff0000, v54
    v_add_f32 v52, v52, v50
    v_add_f32 v53, v53, v51
    v_cvt_pk_bf16_f32 v102, v52, v53
    v_lshlrev_b32 v50, 16, v103
    v_and_b32 v51, 0xffff0000, v103
    v_sub_f32 v52, v50, v40
    v_sub_f32 v53, v51, v40
    v_cvt_pk_bf16_f32 v54, v52, v53
    v_lshlrev_b32 v52, 16, v54
    v_and_b32 v53, 0xffff0000, v54
    v_mul_f32 v52, v52, v41
    v_mul_f32 v53, v53, v41
    v_cvt_pk_bf16_f32 v54, v52, v53
    v_lshlrev_b32 v52, 16, v54
    v_and_b32 v53, 0xffff0000, v54
    v_add_f32 v52, v52, v50
    v_add_f32 v53, v53, v51
    v_cvt_pk_bf16_f32 v103, v52, v53
    buffer_store_dwordx4 v[100:103], v4, s[12:15], 0 offen
    v_lshlrev_b32 v50, 16, v104
    v_and_b32 v51, 0xffff0000, v104
    v_sub_f32 v52, v50, v43
    v_sub_f32 v53, v51, v43
    v_cvt_pk_bf16_f32 v54, v52, v53
    v_lshlrev_b32 v52, 16, v54
    v_and_b32 v53, 0xffff0000, v54
    v_mul_f32 v52, v52, v44
    v_mul_f32 v53, v53, v44
    v_cvt_pk_bf16_f32 v54, v52, v53
    v_lshlrev_b32 v52, 16, v54
    v_and_b32 v53, 0xffff0000, v54
    v_add_f32 v52, v52, v50
    v_add_f32 v53, v53, v51
    v_cvt_pk_bf16_f32 v104, v52, v53
    v_lshlrev_b32 v50, 16, v105
    v_and_b32 v51, 0xffff0000, v105
    v_sub_f32 v52, v50, v43
    v_sub_f32 v53, v51, v43
    v_cvt_pk_bf16_f32 v54, v52, v53
    v_lshlrev_b32 v52, 16, v54
    v_and_b32 v53, 0xffff0000, v54
    v_mul_f32 v52, v52, v44
    v_mul_f32 v53, v53, v44
    v_cvt_pk_bf16_f32 v54, v52, v53
    v_lshlrev_b32 v52, 16, v54
    v_and_b32 v53, 0xffff0000, v54
    v_add_f32 v52, v52, v50
    v_add_f32 v53, v53, v51
    v_cvt_pk_bf16_f32 v105, v52, v53
    v_lshlrev_b32 v50, 16, v106
    v_and_b32 v51, 0xffff0000, v106
    v_sub_f32 v52, v50, v43
    v_sub_f32 v53, v51, v43
    v_cvt_pk_bf16_f32 v54, v52, v53
    v_lshlrev_b32 v52, 16, v54
    v_and_b32 v53, 0xffff0000, v54
    v_mul_f32 v52, v52, v44
    v_mul_f32 v53, v53, v44
    v_cvt_pk_bf16_f32 v54, v52, v53
    v_lshlrev_b32 v52, 16, v54
    v_and_b32 v53, 0xffff0000, v54
    v_add_f32 v52, v52, v50
    v_add_f32 v53, v53, v51
    v_cvt_pk_bf16_f32 v106, v52, v53
    v_lshlrev_b32 v50, 16, v107
    v_and_b32 v51, 0xffff0000, v107
    v_sub_f32 v52, v50, v43
    v_sub_f32 v53, v51, v43
    v_cvt_pk_bf16_f32 v54, v52, v53
    v_lshlrev_b32 v52, 16, v54
    v_and_b32 v53, 0xffff0000, v54
    v_mul_f32 v52, v52, v44
    v_mul_f32 v53, v53, v44
    v_cvt_pk_bf16_f32 v54, v52, v53
    v_lshlrev_b32 v52, 16, v54
    v_and_b32 v53, 0xffff0000, v54
    v_add_f32 v52, v52, v50
    v_add_f32 v53, v53, v51
    v_cvt_pk_bf16_f32 v107, v52, v53
    buffer_store_dwordx4 v[104:107], v5, s[12:15], 0 offen
    s_mul_i32 s34, s33, 16896
    v_lshlrev_b32 v7, 4, v1
    v_add_u32 v7, s34, v7

    s_waitcnt vmcnt(2)
    s_barrier
    ds_write_b128 v7, v[112:115] offset:0
    ds_write_b128 v7, v[116:119] offset:1056
    ds_write_b128 v7, v[120:123] offset:2112
    ds_write_b128 v7, v[124:127] offset:3168
    ds_write_b128 v7, v[128:131] offset:8448
    ds_write_b128 v7, v[132:135] offset:9504
    ds_write_b128 v7, v[136:139] offset:10560
    ds_write_b128 v7, v[140:143] offset:11616
    ds_write_b128 v7, v[144:147] offset:4224
    ds_write_b128 v7, v[148:151] offset:5280
    ds_write_b128 v7, v[152:155] offset:6336
    ds_write_b128 v7, v[156:159] offset:7392
    ds_write_b128 v7, v[160:163] offset:12672
    ds_write_b128 v7, v[164:167] offset:13728
    ds_write_b128 v7, v[168:171] offset:14784
    ds_write_b128 v7, v[172:175] offset:15840
    s_waitcnt lgkmcnt(0)
    s_barrier
    s_endpgm
L_k3s_mm:
    s_cmp_ge_u32 s2, 28
    s_cbranch_scc1 L_k3s_end
    s_lshl_b32 s34, s33, 2
    v_mov_b32 v2, s34
    v_add_u32 v2, 158400, v2
    v_mov_b32 v3, 0
    ds_write_b32 v2, v3

    s_setprio 3
    s_waitcnt lgkmcnt(0)
    s_barrier
    s_add_u32 s4, s24, 0x600000
    s_addc_u32 s5, s25, 0
    s_mov_b32 s6, 0x8000
    s_mov_b32 s7, 0x00020000
    s_add_u32 s8, s24, 0x200000
    s_addc_u32 s9, s25, 0
    s_mov_b32 s10, 0x200000
    s_mov_b32 s11, 0x00020000
    s_mov_b32 s16, s20
    s_mov_b32 s17, s21
    s_mov_b32 s18, 0x400
    s_mov_b32 s19, 0x00020000
    s_add_u32 s44, s24, 0x620000
    s_addc_u32 s45, s25, 0
    s_mov_b32 s46, 0x40
    s_mov_b32 s47, 0x00020000
    s_add_u32 s48, s24, 0x630000
    s_addc_u32 s49, s25, 0
    s_mov_b32 s50, 0x2000
    s_mov_b32 s51, 0x00020000
    s_add_u32 s52, s24, 0x800000
    s_addc_u32 s53, s25, 0
    s_mov_b32 s54, 0x70000
    s_mov_b32 s55, 0x00020000
    v_lshlrev_b32 v2, 5, v0
    s_mov_b32 s34, 8192
    s_mov_b32 s35, 16384
    buffer_load_dwordx4 v[64:67], v2, s[4:7], 0 offen offset:0
    buffer_load_dwordx4 v[68:71], v2, s[4:7], 0 offen offset:16
    buffer_load_dwordx4 v[72:75], v2, s[4:7], s34 offen offset:0
    buffer_load_dwordx4 v[76:79], v2, s[4:7], s34 offen offset:16
    buffer_load_dwordx4 v[80:83], v2, s[4:7], s35 offen offset:0
    buffer_load_dwordx4 v[84:87], v2, s[4:7], s35 offen offset:16
    v_lshlrev_b32 v3, 4, v1
    buffer_load_dwordx4 v[96:99], v3, s[16:19], 0 offen
    s_waitcnt vmcnt(0)
L_k3s_r1:
    v_mov_b32 v8, 0
    v_dot2_f32_bf16 v8, v96, s58, v8
    v_dot2_f32_bf16 v8, v97, s58, v8
    v_dot2_f32_bf16 v8, v98, s58, v8
    v_dot2_f32_bf16 v8, v99, s58, v8
    s_nop 2
    v_add_f32_dpp v8, v8, v8 row_ror:1 row_mask:0xf bank_mask:0xf
    s_nop 1
    v_add_f32_dpp v8, v8, v8 row_ror:2 row_mask:0xf bank_mask:0xf
    s_nop 1
    v_add_f32_dpp v8, v8, v8 row_ror:4 row_mask:0xf bank_mask:0xf
    s_nop 1
    v_add_f32_dpp v8, v8, v8 row_ror:8 row_mask:0xf bank_mask:0xf
    s_nop 1
    v_mov_b32 v9, v8
    s_nop 1
    v_permlane16_swap_b32 v8, v9
    s_nop 0
    v_add_f32 v8, v8, v9
    v_mov_b32 v9, v8
    s_nop 1
    v_permlane32_swap_b32 v8, v9
    s_nop 0
    v_add_f32 v8, v8, v9
    v_lshlrev_b32 v10, 5, v0
    v_lshlrev_b32 v11, 3, v0
    v_sub_u32 v11, 2047, v11
    v_add_u32 v10, 131072, v10
    s_mov_b32 s59, 0xffff0000
    v_mov_b32 v9, v8
    v_mov_b32 v2, s56
    v_mov_b32 v3, s56
    v_mov_b32 v4, s57
    v_mov_b32 v5, s57
    v_pk_mul_f32 v[64:65], v[64:65], v[2:3]
    v_pk_mul_f32 v[72:73], v[72:73], v[2:3]
    v_pk_mul_f32 v[66:67], v[66:67], v[2:3]
    v_pk_mul_f32 v[74:75], v[74:75], v[2:3]
    v_pk_mul_f32 v[68:69], v[68:69], v[2:3]
    v_pk_mul_f32 v[76:77], v[76:77], v[2:3]
    v_pk_mul_f32 v[70:71], v[70:71], v[2:3]
    v_pk_mul_f32 v[78:79], v[78:79], v[2:3]
    v_pk_fma_f32 v[72:73], v[64:65], v[64:65], v[72:73] neg_lo:[1,0,0] neg_hi:[1,0,0]
    v_cvt_pk_bf16_f32 v88, v64, v65
    v_pk_fma_f32 v[74:75], v[66:67], v[66:67], v[74:75] neg_lo:[1,0,0] neg_hi:[1,0,0]
    v_cvt_pk_bf16_f32 v89, v66, v67
    v_pk_fma_f32 v[76:77], v[68:69], v[68:69], v[76:77] neg_lo:[1,0,0] neg_hi:[1,0,0]
    v_cvt_pk_bf16_f32 v90, v68, v69
    v_pk_fma_f32 v[78:79], v[70:71], v[70:71], v[78:79] neg_lo:[1,0,0] neg_hi:[1,0,0]
    v_cvt_pk_bf16_f32 v91, v70, v71
    v_max_f32 v72, 0, v72
    v_max_f32 v73, 0, v73
    v_lshlrev_b32 v64, 16, v88
    v_and_b32 v65, s59, v88
    v_max_f32 v74, 0, v74
    v_max_f32 v75, 0, v75
    v_lshlrev_b32 v66, 16, v89
    v_and_b32 v67, s59, v89
    v_max_f32 v76, 0, v76
    v_max_f32 v77, 0, v77
    v_lshlrev_b32 v68, 16, v90
    v_and_b32 v69, s59, v90
    v_max_f32 v78, 0, v78
    v_max_f32 v79, 0, v79
    v_lshlrev_b32 v70, 16, v91
    v_and_b32 v71, s59, v91
    v_cvt_pk_bf16_f32 v92, v72, v73
    v_pk_fma_f32 v[80:81], v[64:65], v[8:9], v[80:81] neg_lo:[1,0,0] neg_hi:[1,0,0]
    v_cvt_pk_bf16_f32 v93, v74, v75
    v_pk_fma_f32 v[82:83], v[66:67], v[8:9], v[82:83] neg_lo:[1,0,0] neg_hi:[1,0,0]
    v_cvt_pk_bf16_f32 v94, v76, v77
    v_pk_fma_f32 v[84:85], v[68:69], v[8:9], v[84:85] neg_lo:[1,0,0] neg_hi:[1,0,0]
    v_cvt_pk_bf16_f32 v95, v78, v79
    v_pk_fma_f32 v[86:87], v[70:71], v[8:9], v[86:87] neg_lo:[1,0,0] neg_hi:[1,0,0]
    v_lshlrev_b32 v72, 16, v92
    v_and_b32 v73, s59, v92
    v_lshlrev_b32 v74, 16, v93
    v_and_b32 v75, s59, v93
    v_lshlrev_b32 v76, 16, v94
    v_and_b32 v77, s59, v94
    v_lshlrev_b32 v78, 16, v95
    v_and_b32 v79, s59, v95
    v_pk_add_f32 v[72:73], v[72:73], v[4:5]
    v_pk_add_f32 v[74:75], v[74:75], v[4:5]
    v_pk_add_f32 v[76:77], v[76:77], v[4:5]
    v_pk_add_f32 v[78:79], v[78:79], v[4:5]
    v_cvt_pk_bf16_f32 v92, v72, v73
    v_cvt_pk_bf16_f32 v93, v74, v75
    v_cvt_pk_bf16_f32 v94, v76, v77
    v_cvt_pk_bf16_f32 v95, v78, v79
    v_lshlrev_b32 v72, 16, v92
    v_and_b32 v73, s59, v92
    v_lshlrev_b32 v74, 16, v93
    v_and_b32 v75, s59, v93
    v_lshlrev_b32 v76, 16, v94
    v_and_b32 v77, s59, v94
    v_lshlrev_b32 v78, 16, v95
    v_and_b32 v79, s59, v95
    v_sqrt_f32 v72, v72
    v_sqrt_f32 v73, v73
    v_sqrt_f32 v74, v74
    v_sqrt_f32 v75, v75
    v_sqrt_f32 v76, v76
    v_sqrt_f32 v77, v77
    v_sqrt_f32 v78, v78
    v_sqrt_f32 v79, v79
    s_nop 0
    v_cvt_pk_bf16_f32 v92, v72, v73
    v_cvt_pk_bf16_f32 v93, v74, v75
    v_cvt_pk_bf16_f32 v94, v76, v77
    v_cvt_pk_bf16_f32 v95, v78, v79
    v_lshlrev_b32 v72, 16, v92
    v_and_b32 v73, s59, v92
    v_lshlrev_b32 v74, 16, v93
    v_and_b32 v75, s59, v93
    v_lshlrev_b32 v76, 16, v94
    v_and_b32 v77, s59, v94
    v_lshlrev_b32 v78, 16, v95
    v_and_b32 v79, s59, v95
    v_rcp_f32 v72, v72
    v_rcp_f32 v73, v73
    v_rcp_f32 v74, v74
    v_rcp_f32 v75, v75
    v_rcp_f32 v76, v76
    v_rcp_f32 v77, v77
    v_rcp_f32 v78, v78
    v_rcp_f32 v79, v79
    s_nop 0
    v_pk_mul_f32 v[80:81], v[80:81], v[72:73]
    v_pk_mul_f32 v[82:83], v[82:83], v[74:75]
    v_pk_mul_f32 v[84:85], v[84:85], v[76:77]
    v_pk_mul_f32 v[86:87], v[86:87], v[78:79]
    v_cvt_pk_bf16_f32 v92, v80, v81
    v_cvt_pk_bf16_f32 v93, v82, v83
    v_cvt_pk_bf16_f32 v94, v84, v85
    v_cvt_pk_bf16_f32 v95, v86, v87
    v_lshlrev_b32 v80, 16, v92
    v_and_b32 v81, s59, v92
    v_lshlrev_b32 v82, 16, v93
    v_and_b32 v83, s59, v93
    v_lshlrev_b32 v84, 16, v94
    v_and_b32 v85, s59, v94
    v_lshlrev_b32 v86, 16, v95
    v_and_b32 v87, s59, v95
    v_ashrrev_i32 v20, 31, v80
    v_ashrrev_i32 v21, 31, v81
    v_ashrrev_i32 v22, 31, v82
    v_ashrrev_i32 v23, 31, v83
    v_ashrrev_i32 v24, 31, v84
    v_ashrrev_i32 v25, 31, v85
    v_ashrrev_i32 v26, 31, v86
    v_ashrrev_i32 v27, 31, v87
    v_or_b32 v20, 0x80000000, v20
    v_or_b32 v21, 0x80000000, v21
    v_or_b32 v22, 0x80000000, v22
    v_or_b32 v23, 0x80000000, v23
    v_or_b32 v24, 0x80000000, v24
    v_or_b32 v25, 0x80000000, v25
    v_or_b32 v26, 0x80000000, v26
    v_or_b32 v27, 0x80000000, v27
    v_xor_b32 v80, v80, v20
    v_xor_b32 v81, v81, v21
    v_xor_b32 v82, v82, v22
    v_xor_b32 v83, v83, v23
    v_xor_b32 v84, v84, v24
    v_xor_b32 v85, v85, v25
    v_xor_b32 v86, v86, v26
    v_xor_b32 v87, v87, v27
    v_subrev_u32 v20, 0, v11
    v_subrev_u32 v21, 1, v11
    v_subrev_u32 v22, 2, v11
    v_subrev_u32 v23, 3, v11
    v_subrev_u32 v24, 4, v11
    v_subrev_u32 v25, 5, v11
    v_subrev_u32 v26, 6, v11
    v_subrev_u32 v27, 7, v11
    v_and_or_b32 v20, v80, s59, v20
    v_and_or_b32 v21, v81, s59, v21
    v_and_or_b32 v22, v82, s59, v22
    v_and_or_b32 v23, v83, s59, v23
    v_and_or_b32 v24, v84, s59, v24
    v_and_or_b32 v25, v85, s59, v25
    v_and_or_b32 v26, v86, s59, v26
    v_and_or_b32 v27, v87, s59, v27
    v_max_u32 v88, v20, v21
    v_max_u32 v89, v22, v23
    v_max_u32 v90, v24, v25
    v_max_u32 v91, v26, v27
    v_min_u32 v21, v20, v21
    v_min_u32 v23, v22, v23
    v_min_u32 v25, v24, v25
    v_min_u32 v27, v26, v27
    v_mov_b32 v20, v88
    v_mov_b32 v22, v89
    v_mov_b32 v24, v90
    v_mov_b32 v26, v91
    v_max_u32 v88, v20, v22
    v_max_u32 v89, v21, v23
    v_max_u32 v90, v24, v26
    v_max_u32 v91, v25, v27
    v_min_u32 v22, v20, v22
    v_min_u32 v23, v21, v23
    v_min_u32 v26, v24, v26
    v_min_u32 v27, v25, v27
    v_mov_b32 v20, v88
    v_mov_b32 v21, v89
    v_mov_b32 v24, v90
    v_mov_b32 v25, v91
    v_max_u32 v88, v21, v22
    v_max_u32 v89, v25, v26
    v_min_u32 v22, v21, v22
    v_min_u32 v26, v25, v26
    v_mov_b32 v21, v88
    v_mov_b32 v25, v89
    v_max_u32 v88, v20, v24
    v_max_u32 v89, v21, v25
    v_max_u32 v90, v22, v26
    v_max_u32 v91, v23, v27
    v_min_u32 v24, v20, v24
    v_min_u32 v25, v21, v25
    v_min_u32 v26, v22, v26
    v_min_u32 v27, v23, v27
    v_mov_b32 v20, v88
    v_mov_b32 v21, v89
    v_mov_b32 v22, v90
    v_mov_b32 v23, v91
    v_max_u32 v88, v22, v24
    v_max_u32 v89, v23, v25
    v_min_u32 v24, v22, v24
    v_min_u32 v25, v23, v25
    v_mov_b32 v22, v88
    v_mov_b32 v23, v89
    v_max_u32 v88, v21, v22
    v_max_u32 v89, v23, v24
    v_max_u32 v90, v25, v26
    v_min_u32 v22, v21, v22
    v_min_u32 v24, v23, v24
    v_min_u32 v26, v25, v26
    v_mov_b32 v21, v88
    v_mov_b32 v23, v89
    v_mov_b32 v25, v90
    v_mov_b32 v30, 0
    v_mov_b32 v31, 0
    s_mov_b32 s34, 0
L_k3s_rd:
    v_mov_b32 v12, v20
    s_nop 1
    v_max_u32_dpp v12, v12, v12 row_ror:1 row_mask:0xf bank_mask:0xf
    s_nop 1
    v_max_u32_dpp v12, v12, v12 row_ror:2 row_mask:0xf bank_mask:0xf
    s_nop 1
    v_max_u32_dpp v12, v12, v12 row_ror:4 row_mask:0xf bank_mask:0xf
    s_nop 1
    v_max_u32_dpp v12, v12, v12 row_ror:8 row_mask:0xf bank_mask:0xf
    s_nop 1
    v_mov_b32 v13, v12
    s_nop 1
    v_permlane16_swap_b32 v12, v13
    s_nop 0
    v_max_u32 v12, v12, v13
    v_mov_b32 v13, v12
    s_nop 1
    v_permlane32_swap_b32 v12, v13
    s_nop 0
    v_max_u32 v12, v12, v13
    v_cmp_eq_u32 vcc, v12, v20
    v_cmp_eq_u32 s[60:61], s34, v1
    s_add_u32 s34, s34, 1
    v_cndmask_b32 v20, v20, v21, vcc
    v_cndmask_b32 v21, v21, v22, vcc
    v_cndmask_b32 v22, v22, v23, vcc
    v_cndmask_b32 v23, v23, v24, vcc
    v_cndmask_b32 v24, v24, v25, vcc
    v_cndmask_b32 v25, v25, v26, vcc
    v_cndmask_b32 v26, v26, v27, vcc
    v_cndmask_b32 v27, v27, v31, vcc
    v_cndmask_b32 v30, v30, v12, s[60:61]
    s_cmp_lt_u32 s34, 8
    s_cbranch_scc1 L_k3s_rd
    ds_write_b128 v10, v[64:67]
    ds_write_b128 v10, v[68:71] offset:16
    ds_write_b128 v10, v[72:75] offset:8192
    ds_write_b128 v10, v[76:79] offset:8208
    s_lshl_b32 s34, s33, 5
    v_lshlrev_b32 v12, 2, v1
    v_add_u32 v12, s34, v12
    v_add_u32 v12, 158144, v12
    v_cmp_gt_u32 vcc, 8, v1
    s_and_saveexec_b64 s[62:63], vcc
    ds_write_b32 v12, v30
    s_mov_b64 exec, s[62:63]
    s_lshl_b32 s34, s33, 2
    v_mov_b32 v12, s34
    v_add_u32 v12, 158400, v12
    v_mov_b32 v13, 1
    ds_write_b32 v12, v13
    v_mov_b32 v12, 158400

L_k3s_poll:
    ds_read_b128 v[32:35], v12
    s_waitcnt lgkmcnt(0)
    v_and_b32 v32, v32, v33
    v_and_b32 v34, v34, v35
    v_and_b32 v32, v32, v34
    v_cmp_eq_u32 vcc, 1, v32
    s_cbranch_vccz L_k3s_poll

    v_and_b32 v12, 31, v1
    v_lshlrev_b32 v12, 2, v12
    v_add_u32 v12, 158144, v12
    ds_read_b32 v30, v12
    v_mov_b32 v13, 158144
    ds_read_b128 v[32:35], v13 offset:0
    ds_read_b128 v[36:39], v13 offset:16
    ds_read_b128 v[40:43], v13 offset:32
    ds_read_b128 v[44:47], v13 offset:48
    ds_read_b128 v[48:51], v13 offset:64
    ds_read_b128 v[52:55], v13 offset:80
    ds_read_b128 v[56:59], v13 offset:96
    ds_read_b128 v[60:63], v13 offset:112
    v_mov_b32 v14, 0
    s_waitcnt lgkmcnt(0)
    v_cmp_gt_u32 vcc, v32, v30
    v_addc_co_u32 v14, vcc, 0, v14, vcc
    v_cmp_gt_u32 vcc, v33, v30
    v_addc_co_u32 v14, vcc, 0, v14, vcc
    v_cmp_gt_u32 vcc, v34, v30
    v_addc_co_u32 v14, vcc, 0, v14, vcc
    v_cmp_gt_u32 vcc, v35, v30
    v_addc_co_u32 v14, vcc, 0, v14, vcc
    v_cmp_gt_u32 vcc, v36, v30
    v_addc_co_u32 v14, vcc, 0, v14, vcc
    v_cmp_gt_u32 vcc, v37, v30
    v_addc_co_u32 v14, vcc, 0, v14, vcc
    v_cmp_gt_u32 vcc, v38, v30
    v_addc_co_u32 v14, vcc, 0, v14, vcc
    v_cmp_gt_u32 vcc, v39, v30
    v_addc_co_u32 v14, vcc, 0, v14, vcc
    v_cmp_gt_u32 vcc, v40, v30
    v_addc_co_u32 v14, vcc, 0, v14, vcc
    v_cmp_gt_u32 vcc, v41, v30
    v_addc_co_u32 v14, vcc, 0, v14, vcc
    v_cmp_gt_u32 vcc, v42, v30
    v_addc_co_u32 v14, vcc, 0, v14, vcc
    v_cmp_gt_u32 vcc, v43, v30
    v_addc_co_u32 v14, vcc, 0, v14, vcc
    v_cmp_gt_u32 vcc, v44, v30
    v_addc_co_u32 v14, vcc, 0, v14, vcc
    v_cmp_gt_u32 vcc, v45, v30
    v_addc_co_u32 v14, vcc, 0, v14, vcc
    v_cmp_gt_u32 vcc, v46, v30
    v_addc_co_u32 v14, vcc, 0, v14, vcc
    v_cmp_gt_u32 vcc, v47, v30
    v_addc_co_u32 v14, vcc, 0, v14, vcc
    v_cmp_gt_u32 vcc, v48, v30
    v_addc_co_u32 v14, vcc, 0, v14, vcc
    v_cmp_gt_u32 vcc, v49, v30
    v_addc_co_u32 v14, vcc, 0, v14, vcc
    v_cmp_gt_u32 vcc, v50, v30
    v_addc_co_u32 v14, vcc, 0, v14, vcc
    v_cmp_gt_u32 vcc, v51, v30
    v_addc_co_u32 v14, vcc, 0, v14, vcc
    v_cmp_gt_u32 vcc, v52, v30
    v_addc_co_u32 v14, vcc, 0, v14, vcc
    v_cmp_gt_u32 vcc, v53, v30
    v_addc_co_u32 v14, vcc, 0, v14, vcc
    v_cmp_gt_u32 vcc, v54, v30
    v_addc_co_u32 v14, vcc, 0, v14, vcc
    v_cmp_gt_u32 vcc, v55, v30
    v_addc_co_u32 v14, vcc, 0, v14, vcc
    v_cmp_gt_u32 vcc, v56, v30
    v_addc_co_u32 v14, vcc, 0, v14, vcc
    v_cmp_gt_u32 vcc, v57, v30
    v_addc_co_u32 v14, vcc, 0, v14, vcc
    v_cmp_gt_u32 vcc, v58, v30
    v_addc_co_u32 v14, vcc, 0, v14, vcc
    v_cmp_gt_u32 vcc, v59, v30
    v_addc_co_u32 v14, vcc, 0, v14, vcc
    v_cmp_gt_u32 vcc, v60, v30
    v_addc_co_u32 v14, vcc, 0, v14, vcc
    v_cmp_gt_u32 vcc, v61, v30
    v_addc_co_u32 v14, vcc, 0, v14, vcc
    v_cmp_gt_u32 vcc, v62, v30
    v_addc_co_u32 v14, vcc, 0, v14, vcc
    v_cmp_gt_u32 vcc, v63, v30
    v_addc_co_u32 v14, vcc, 0, v14, vcc
    v_cmp_gt_u32 vcc, 8, v14
    v_cmp_gt_u32 s[60:61], 32, v1
    s_and_b64 vcc, vcc, s[60:61]
    v_lshlrev_b32 v14, 2, v14
    v_add_u32 v14, 158272, v14
    s_and_saveexec_b64 s[62:63], vcc
    ds_write_b32 v14, v30
    s_mov_b64 exec, s[62:63]
    s_waitcnt lgkmcnt(0)
    v_lshrrev_b32 v12, 5, v0
    v_lshlrev_b32 v12, 2, v12
    v_add_u32 v12, 158272, v12
    ds_read_b32 v31, v12
    s_waitcnt lgkmcnt(0)
    v_and_b32 v13, 0xffff, v31
    v_sub_u32 v13, 2047, v13
    v_lshlrev_b32 v14, 10, v13
    v_and_b32 v15, 31, v0
    v_lshl_add_u32 v14, v15, 5, v14
    buffer_load_dwordx4 v[32:35], v14, s[8:11], 0 offen
    buffer_load_dwordx4 v[36:39], v14, s[8:11], 0 offen offset:16
    v_lshlrev_b32 v16, 2, v13
    v_add_u32 v16, 131072, v16
    ds_read_b32 v40, v16
    ds_read_b32 v41, v16 offset:8192

    v_lshrrev_b32 v12, 5, v0
    v_mul_u32_u24 v12, 1040, v12
    v_lshl_add_u32 v12, v15, 5, v12
    v_add_u32 v12, 147456, v12
    v_lshrrev_b32 v11, 4, v1
    v_bfe_u32 v10, v1, 2, 2
    v_lshl_add_u32 v17, v11, 3, v10
    v_lshlrev_b32 v17, 7, v17
    v_lshrrev_b32 v18, 1, v10
    v_and_b32 v19, 1, v11
    v_lshl_or_b32 v18, v19, 1, v18
    v_xor_b32 v18, s33, v18
    v_lshl_add_u32 v17, v18, 5, v17
    v_and_b32 v18, 3, v1
    v_lshl_add_u32 v8, v18, 3, v17
    v_add_u32 v9, 65536, v8
    v_and_b32 v17, 7, v1
    v_mul_u32_u24 v17, 1040, v17
    v_lshl_add_u32 v17, v11, 4, v17
    v_add_u32 v17, 147456, v17

    v_mov_b32 v121, v14
    s_waitcnt vmcnt(0) lgkmcnt(0)
    v_lshlrev_b32 v50, 16, v32
    v_and_b32 v51, 0xffff0000, v32
    v_sub_f32 v52, v50, v40
    v_sub_f32 v53, v51, v40
    v_cvt_pk_bf16_f32 v54, v52, v53
    v_lshlrev_b32 v52, 16, v54
    v_and_b32 v53, 0xffff0000, v54
    v_mul_f32 v52, v52, v41
    v_mul_f32 v53, v53, v41
    v_cvt_pk_bf16_f32 v32, v52, v53
    v_lshlrev_b32 v50, 16, v33
    v_and_b32 v51, 0xffff0000, v33
    v_sub_f32 v52, v50, v40
    v_sub_f32 v53, v51, v40
    v_cvt_pk_bf16_f32 v54, v52, v53
    v_lshlrev_b32 v52, 16, v54
    v_and_b32 v53, 0xffff0000, v54
    v_mul_f32 v52, v52, v41
    v_mul_f32 v53, v53, v41
    v_cvt_pk_bf16_f32 v33, v52, v53
    v_lshlrev_b32 v50, 16, v34
    v_and_b32 v51, 0xffff0000, v34
    v_sub_f32 v52, v50, v40
    v_sub_f32 v53, v51, v40
    v_cvt_pk_bf16_f32 v54, v52, v53
    v_lshlrev_b32 v52, 16, v54
    v_and_b32 v53, 0xffff0000, v54
    v_mul_f32 v52, v52, v41
    v_mul_f32 v53, v53, v41
    v_cvt_pk_bf16_f32 v34, v52, v53
    v_lshlrev_b32 v50, 16, v35
    v_and_b32 v51, 0xffff0000, v35
    v_sub_f32 v52, v50, v40
    v_sub_f32 v53, v51, v40
    v_cvt_pk_bf16_f32 v54, v52, v53
    v_lshlrev_b32 v52, 16, v54
    v_and_b32 v53, 0xffff0000, v54
    v_mul_f32 v52, v52, v41
    v_mul_f32 v53, v53, v41
    v_cvt_pk_bf16_f32 v35, v52, v53
    v_lshlrev_b32 v50, 16, v36
    v_and_b32 v51, 0xffff0000, v36
    v_sub_f32 v52, v50, v40
    v_sub_f32 v53, v51, v40
    v_cvt_pk_bf16_f32 v54, v52, v53
    v_lshlrev_b32 v52, 16, v54
    v_and_b32 v53, 0xffff0000, v54
    v_mul_f32 v52, v52, v41
    v_mul_f32 v53, v53, v41
    v_cvt_pk_bf16_f32 v36, v52, v53
    v_lshlrev_b32 v50, 16, v37
    v_and_b32 v51, 0xffff0000, v37
    v_sub_f32 v52, v50, v40
    v_sub_f32 v53, v51, v40
    v_cvt_pk_bf16_f32 v54, v52, v53
    v_lshlrev_b32 v52, 16, v54
    v_and_b32 v53, 0xffff0000, v54
    v_mul_f32 v52, v52, v41
    v_mul_f32 v53, v53, v41
    v_cvt_pk_bf16_f32 v37, v52, v53
    v_lshlrev_b32 v50, 16, v38
    v_and_b32 v51, 0xffff0000, v38
    v_sub_f32 v52, v50, v40
    v_sub_f32 v53, v51, v40
    v_cvt_pk_bf16_f32 v54, v52, v53
    v_lshlrev_b32 v52, 16, v54
    v_and_b32 v53, 0xffff0000, v54
    v_mul_f32 v52, v52, v41
    v_mul_f32 v53, v53, v41
    v_cvt_pk_bf16_f32 v38, v52, v53
    v_lshlrev_b32 v50, 16, v39
    v_and_b32 v51, 0xffff0000, v39
    v_sub_f32 v52, v50, v40
    v_sub_f32 v53, v51, v40
    v_cvt_pk_bf16_f32 v54, v52, v53
    v_lshlrev_b32 v52, 16, v54
    v_and_b32 v53, 0xffff0000, v54
    v_mul_f32 v52, v52, v41
    v_mul_f32 v53, v53, v41
    v_cvt_pk_bf16_f32 v39, v52, v53
    ds_write_b128 v12, v[32:35]
    ds_write_b128 v12, v[36:39] offset:16
    v_and_b32 v51, 0xffff0000, v31
    v_ashrrev_i32 v50, 31, v51
    v_not_b32 v50, v50
    v_or_b32 v50, 0x80000000, v50
    v_xor_b32 v51, v51, v50
    v_and_b32 v51, 0xffff0000, v51
    v_mul_f32 v52, 0xbfb8aa3b, v51
    v_exp_f32 v52, v52
    s_nop 0
    v_add_f32 v52, 1.0, v52
    v_rcp_f32 v52, v52
    s_nop 0
    v_cvt_pk_bf16_f32 v52, v52, v52
    v_lshlrev_b32 v52, 16, v52

    s_cmp_lg_u32 s2, 0
    s_cbranch_scc1 L_k3s_nopub
    v_lshlrev_b32 v12, 5, v0
    buffer_store_dwordx4 v[32:35], v12, s[48:51], 0 offen
    buffer_store_dwordx4 v[36:39], v12, s[48:51], 0 offen offset:16
    v_lshrrev_b32 v12, 5, v0
    v_lshlrev_b32 v12, 2, v12
    v_and_b32 v15, 31, v0
    v_cmp_eq_u32 vcc, 0, v15
    v_mov_b32 v53, 0x7ffffff0
    s_nop 0
    v_cndmask_b32 v12, v53, v12, vcc
    buffer_store_dword v13, v12, s[44:47], 0 offen
    buffer_store_dword v52, v12, s[44:47], 0 offen offset:32

L_k3s_nopub:
    s_waitcnt lgkmcnt(0)
    s_barrier
    ds_read_b64_tr_b16 v[128:129], v8 offset:0
    ds_read_b64_tr_b16 v[130:131], v8 offset:512
    ds_read_b64_tr_b16 v[132:133], v9 offset:0
    ds_read_b64_tr_b16 v[134:135], v9 offset:512
    ds_read_b128 v[136:139], v17 offset:0
    ds_read_b64_tr_b16 v[140:141], v8 offset:4096
    ds_read_b64_tr_b16 v[142:143], v8 offset:4608
    ds_read_b64_tr_b16 v[144:145], v9 offset:4096
    ds_read_b64_tr_b16 v[146:147], v9 offset:4608
    ds_read_b128 v[148:151], v17 offset:64
    ds_read_b64_tr_b16 v[152:153], v8 offset:8192
    ds_read_b64_tr_b16 v[154:155], v8 offset:8704
    ds_read_b64_tr_b16 v[156:157], v9 offset:8192
    ds_read_b64_tr_b16 v[158:159], v9 offset:8704
    ds_read_b128 v[160:163], v17 offset:128
    s_waitcnt lgkmcnt(10)
    v_mfma_f32_16x16x32_bf16 v[96:99], v[128:131], v[136:139], 0
    v_mfma_f32_16x16x32_bf16 v[100:103], v[132:135], v[136:139], 0
    ds_read_b64_tr_b16 v[164:165], v8 offset:12288
    ds_read_b64_tr_b16 v[166:167], v8 offset:12800
    ds_read_b64_tr_b16 v[168:169], v9 offset:12288
    ds_read_b64_tr_b16 v[170:171], v9 offset:12800
    ds_read_b128 v[172:175], v17 offset:192
    s_waitcnt lgkmcnt(10)
    v_mfma_f32_16x16x32_bf16 v[96:99], v[140:143], v[148:151], v[96:99]
    v_mfma_f32_16x16x32_bf16 v[100:103], v[144:147], v[148:151], v[100:103]
    ds_read_b64_tr_b16 v[128:129], v8 offset:16384
    ds_read_b64_tr_b16 v[130:131], v8 offset:16896
    ds_read_b64_tr_b16 v[132:133], v9 offset:16384
    ds_read_b64_tr_b16 v[134:135], v9 offset:16896
    ds_read_b128 v[136:139], v17 offset:256
    s_waitcnt lgkmcnt(10)
    v_mfma_f32_16x16x32_bf16 v[96:99], v[152:155], v[160:163], v[96:99]
    v_mfma_f32_16x16x32_bf16 v[100:103], v[156:159], v[160:163], v[100:103]
    ds_read_b64_tr_b16 v[140:141], v8 offset:20480
    ds_read_b64_tr_b16 v[142:143], v8 offset:20992
    ds_read_b64_tr_b16 v[144:145], v9 offset:20480
    ds_read_b64_tr_b16 v[146:147], v9 offset:20992
    ds_read_b128 v[148:151], v17 offset:320
    s_waitcnt lgkmcnt(10)
    v_mfma_f32_16x16x32_bf16 v[96:99], v[164:167], v[172:175], v[96:99]
    v_mfma_f32_16x16x32_bf16 v[100:103], v[168:171], v[172:175], v[100:103]
    ds_read_b64_tr_b16 v[152:153], v8 offset:24576
    ds_read_b64_tr_b16 v[154:155], v8 offset:25088
    ds_read_b64_tr_b16 v[156:157], v9 offset:24576
    ds_read_b64_tr_b16 v[158:159], v9 offset:25088
    ds_read_b128 v[160:163], v17 offset:384
    s_waitcnt lgkmcnt(10)
    v_mfma_f32_16x16x32_bf16 v[96:99], v[128:131], v[136:139], v[96:99]
    v_mfma_f32_16x16x32_bf16 v[100:103], v[132:135], v[136:139], v[100:103]
    ds_read_b64_tr_b16 v[164:165], v8 offset:28672
    ds_read_b64_tr_b16 v[166:167], v8 offset:29184
    ds_read_b64_tr_b16 v[168:169], v9 offset:28672
    ds_read_b64_tr_b16 v[170:171], v9 offset:29184
    ds_read_b128 v[172:175], v17 offset:448
    s_waitcnt lgkmcnt(10)
    v_mfma_f32_16x16x32_bf16 v[96:99], v[140:143], v[148:151], v[96:99]
    v_mfma_f32_16x16x32_bf16 v[100:103], v[144:147], v[148:151], v[100:103]
    ds_read_b64_tr_b16 v[128:129], v8 offset:32768
    ds_read_b64_tr_b16 v[130:131], v8 offset:33280
    ds_read_b64_tr_b16 v[132:133], v9 offset:32768
    ds_read_b64_tr_b16 v[134:135], v9 offset:33280
    ds_read_b128 v[136:139], v17 offset:512
    s_waitcnt lgkmcnt(10)
    v_mfma_f32_16x16x32_bf16 v[96:99], v[152:155], v[160:163], v[96:99]
    v_mfma_f32_16x16x32_bf16 v[100:103], v[156:159], v[160:163], v[100:103]
    ds_read_b64_tr_b16 v[140:141], v8 offset:36864
    ds_read_b64_tr_b16 v[142:143], v8 offset:37376
    ds_read_b64_tr_b16 v[144:145], v9 offset:36864
    ds_read_b64_tr_b16 v[146:147], v9 offset:37376
    ds_read_b128 v[148:151], v17 offset:576
    s_waitcnt lgkmcnt(10)
    v_mfma_f32_16x16x32_bf16 v[96:99], v[164:167], v[172:175], v[96:99]
    v_mfma_f32_16x16x32_bf16 v[100:103], v[168:171], v[172:175], v[100:103]
    ds_read_b64_tr_b16 v[152:153], v8 offset:40960
    ds_read_b64_tr_b16 v[154:155], v8 offset:41472
    ds_read_b64_tr_b16 v[156:157], v9 offset:40960
    ds_read_b64_tr_b16 v[158:159], v9 offset:41472
    ds_read_b128 v[160:163], v17 offset:640
    s_waitcnt lgkmcnt(10)
    v_mfma_f32_16x16x32_bf16 v[96:99], v[128:131], v[136:139], v[96:99]
    v_mfma_f32_16x16x32_bf16 v[100:103], v[132:135], v[136:139], v[100:103]
    ds_read_b64_tr_b16 v[164:165], v8 offset:45056
    ds_read_b64_tr_b16 v[166:167], v8 offset:45568
    ds_read_b64_tr_b16 v[168:169], v9 offset:45056
    ds_read_b64_tr_b16 v[170:171], v9 offset:45568
    ds_read_b128 v[172:175], v17 offset:704
    s_waitcnt lgkmcnt(10)
    v_mfma_f32_16x16x32_bf16 v[96:99], v[140:143], v[148:151], v[96:99]
    v_mfma_f32_16x16x32_bf16 v[100:103], v[144:147], v[148:151], v[100:103]
    ds_read_b64_tr_b16 v[128:129], v8 offset:49152
    ds_read_b64_tr_b16 v[130:131], v8 offset:49664
    ds_read_b64_tr_b16 v[132:133], v9 offset:49152
    ds_read_b64_tr_b16 v[134:135], v9 offset:49664
    ds_read_b128 v[136:139], v17 offset:768
    s_waitcnt lgkmcnt(10)
    v_mfma_f32_16x16x32_bf16 v[96:99], v[152:155], v[160:163], v[96:99]
    v_mfma_f32_16x16x32_bf16 v[100:103], v[156:159], v[160:163], v[100:103]
    ds_read_b64_tr_b16 v[140:141], v8 offset:53248
    ds_read_b64_tr_b16 v[142:143], v8 offset:53760
    ds_read_b64_tr_b16 v[144:145], v9 offset:53248
    ds_read_b64_tr_b16 v[146:147], v9 offset:53760
    ds_read_b128 v[148:151], v17 offset:832
    s_waitcnt lgkmcnt(10)
    v_mfma_f32_16x16x32_bf16 v[96:99], v[164:167], v[172:175], v[96:99]
    v_mfma_f32_16x16x32_bf16 v[100:103], v[168:171], v[172:175], v[100:103]
    ds_read_b64_tr_b16 v[152:153], v8 offset:57344
    ds_read_b64_tr_b16 v[154:155], v8 offset:57856
    ds_read_b64_tr_b16 v[156:157], v9 offset:57344
    ds_read_b64_tr_b16 v[158:159], v9 offset:57856
    ds_read_b128 v[160:163], v17 offset:896
    s_waitcnt lgkmcnt(10)
    v_mfma_f32_16x16x32_bf16 v[96:99], v[128:131], v[136:139], v[96:99]
    v_mfma_f32_16x16x32_bf16 v[100:103], v[132:135], v[136:139], v[100:103]
    ds_read_b64_tr_b16 v[164:165], v8 offset:61440
    ds_read_b64_tr_b16 v[166:167], v8 offset:61952
    ds_read_b64_tr_b16 v[168:169], v9 offset:61440
    ds_read_b64_tr_b16 v[170:171], v9 offset:61952
    ds_read_b128 v[172:175], v17 offset:960
    s_waitcnt lgkmcnt(10)
    v_mfma_f32_16x16x32_bf16 v[96:99], v[140:143], v[148:151], v[96:99]
    v_mfma_f32_16x16x32_bf16 v[100:103], v[144:147], v[148:151], v[100:103]
    s_waitcnt lgkmcnt(5)
    v_mfma_f32_16x16x32_bf16 v[96:99], v[152:155], v[160:163], v[96:99]
    v_mfma_f32_16x16x32_bf16 v[100:103], v[156:159], v[160:163], v[100:103]
    s_waitcnt lgkmcnt(0)
    v_mfma_f32_16x16x32_bf16 v[96:99], v[164:167], v[172:175], v[96:99]
    v_mfma_f32_16x16x32_bf16 v[100:103], v[168:171], v[172:175], v[100:103]
    s_barrier
    s_mov_b32 s34, 0xbfb8aa3b
    v_and_b32 v10, 15, v1
    v_mul_u32_u24 v10, 144, v10
    v_lshrrev_b32 v11, 4, v1
    v_lshl_add_u32 v12, v11, 3, v10
    s_lshl_b32 s35, s33, 5
    v_add_u32 v12, s35, v12
    v_add_u32 v12, 155840, v12
    v_lshl_add_u32 v13, v11, 4, v10
    v_add_u32 v13, 155840, v13

    v_cvt_pk_bf16_f32 v96, v96, v96
    v_lshlrev_b32 v96, 16, v96
    v_cvt_pk_bf16_f32 v100, v100, v100
    v_lshlrev_b32 v100, 16, v100
    v_cvt_pk_bf16_f32 v97, v97, v97
    v_lshlrev_b32 v97, 16, v97
    v_cvt_pk_bf16_f32 v101, v101, v101
    v_lshlrev_b32 v101, 16, v101
    v_cvt_pk_bf16_f32 v98, v98, v98
    v_lshlrev_b32 v98, 16, v98
    v_cvt_pk_bf16_f32 v102, v102, v102
    v_lshlrev_b32 v102, 16, v102
    v_cvt_pk_bf16_f32 v99, v99, v99
    v_lshlrev_b32 v99, 16, v99
    v_cvt_pk_bf16_f32 v103, v103, v103
    v_lshlrev_b32 v103, 16, v103
    v_mul_f32 v104, s34, v96
    v_exp_f32 v104, v104
    v_mul_f32 v105, s34, v97
    v_exp_f32 v105, v105
    v_mul_f32 v106, s34, v98
    v_exp_f32 v106, v106
    v_mul_f32 v107, s34, v99
    v_exp_f32 v107, v107
    s_nop 0
    v_add_f32 v104, 1.0, v104
    v_rcp_f32 v104, v104
    v_add_f32 v105, 1.0, v105
    v_rcp_f32 v105, v105
    v_add_f32 v106, 1.0, v106
    v_rcp_f32 v106, v106
    v_add_f32 v107, 1.0, v107
    v_rcp_f32 v107, v107
    s_nop 0
    v_mul_f32 v96, v96, v104
    v_cvt_pk_bf16_f32 v96, v96, v96
    v_lshlrev_b32 v96, 16, v96
    v_mul_f32 v96, v96, v100
    v_mul_f32 v97, v97, v105
    v_cvt_pk_bf16_f32 v97, v97, v97
    v_lshlrev_b32 v97, 16, v97
    v_mul_f32 v97, v97, v101
    v_mul_f32 v98, v98, v106
    v_cvt_pk_bf16_f32 v98, v98, v98
    v_lshlrev_b32 v98, 16, v98
    v_mul_f32 v98, v98, v102
    v_mul_f32 v99, v99, v107
    v_cvt_pk_bf16_f32 v99, v99, v99
    v_lshlrev_b32 v99, 16, v99
    v_mul_f32 v99, v99, v103
    v_cvt_pk_bf16_f32 v96, v96, v97
    v_cvt_pk_bf16_f32 v97, v98, v99
    ds_write_b64 v12, v[96:97]
    v_lshrrev_b32 v10, 5, v1
    v_lshlrev_b32 v8, 4, v10
    v_bfe_u32 v10, v1, 4, 1
    v_lshl_add_u32 v8, v10, 2, v8
    v_bfe_u32 v10, v1, 2, 2
    v_add_u32 v8, v8, v10
    v_mul_u32_u24 v8, 1056, v8
    v_and_b32 v10, 3, v1
    v_lshl_add_u32 v8, v10, 3, v8
    s_lshl_b32 s35, s33, 8
    v_add_u32 v8, s35, v8
    v_and_b32 v10, 15, v1
    v_lshlrev_b32 v14, 11, v10
    v_lshrrev_b32 v11, 4, v1
    v_lshl_add_u32 v14, v11, 4, v14
    s_lshl_b32 s35, s33, 9
    s_lshl_b32 s36, s2, 14
    s_add_u32 s35, s35, s36
    v_add_u32 v14, s35, v14
    v_cmp_gt_u32 vcc, 8, v10
    v_mov_b32 v15, 0x7ffffff0
    s_nop 0
    v_cndmask_b32 v14, v15, v14, vcc

    s_waitcnt lgkmcnt(0)
    s_barrier
    ds_read_b128 v[64:67], v13
    ds_read_b128 v[68:71], v13 offset:64
    ds_read_b64_tr_b16 v[128:129], v8 offset:0
    ds_read_b64_tr_b16 v[130:131], v8 offset:8448
    ds_read_b64_tr_b16 v[132:133], v8 offset:33792
    ds_read_b64_tr_b16 v[134:135], v8 offset:42240
    ds_read_b64_tr_b16 v[136:137], v8 offset:32
    ds_read_b64_tr_b16 v[138:139], v8 offset:8480
    ds_read_b64_tr_b16 v[140:141], v8 offset:33824
    ds_read_b64_tr_b16 v[142:143], v8 offset:42272
    ds_read_b64_tr_b16 v[144:145], v8 offset:64
    ds_read_b64_tr_b16 v[146:147], v8 offset:8512
    ds_read_b64_tr_b16 v[148:149], v8 offset:33856
    ds_read_b64_tr_b16 v[150:151], v8 offset:42304
    ds_read_b64_tr_b16 v[152:153], v8 offset:96
    ds_read_b64_tr_b16 v[154:155], v8 offset:8544
    ds_read_b64_tr_b16 v[156:157], v8 offset:33888
    ds_read_b64_tr_b16 v[158:159], v8 offset:42336
    ds_read_b64_tr_b16 v[160:161], v8 offset:128
    ds_read_b64_tr_b16 v[162:163], v8 offset:8576
    ds_read_b64_tr_b16 v[164:165], v8 offset:33920
    ds_read_b64_tr_b16 v[166:167], v8 offset:42368
    ds_read_b64_tr_b16 v[168:169], v8 offset:160
    ds_read_b64_tr_b16 v[170:171], v8 offset:8608
    ds_read_b64_tr_b16 v[172:173], v8 offset:33952
    ds_read_b64_tr_b16 v[174:175], v8 offset:42400
    ds_read_b64_tr_b16 v[176:177], v8 offset:192
    ds_read_b64_tr_b16 v[178:179], v8 offset:8640
    ds_read_b64_tr_b16 v[180:181], v8 offset:33984
    ds_read_b64_tr_b16 v[182:183], v8 offset:42432
    ds_read_b64_tr_b16 v[184:185], v8 offset:224
    ds_read_b64_tr_b16 v[186:187], v8 offset:8672
    ds_read_b64_tr_b16 v[188:189], v8 offset:34016
    ds_read_b64_tr_b16 v[190:191], v8 offset:42464
    s_waitcnt lgkmcnt(0)
    v_mfma_f32_16x16x32_bf16 v[72:75], v[128:131], v[64:67], 0
    v_mfma_f32_16x16x32_bf16 v[72:75], v[132:135], v[68:71], v[72:75]
    v_mfma_f32_16x16x32_bf16 v[76:79], v[136:139], v[64:67], 0
    v_mfma_f32_16x16x32_bf16 v[76:79], v[140:143], v[68:71], v[76:79]
    v_mfma_f32_16x16x32_bf16 v[80:83], v[144:147], v[64:67], 0
    v_mfma_f32_16x16x32_bf16 v[80:83], v[148:151], v[68:71], v[80:83]
    v_mfma_f32_16x16x32_bf16 v[84:87], v[152:155], v[64:67], 0
    v_mfma_f32_16x16x32_bf16 v[84:87], v[156:159], v[68:71], v[84:87]
    v_mfma_f32_16x16x32_bf16 v[88:91], v[160:163], v[64:67], 0
    v_mfma_f32_16x16x32_bf16 v[88:91], v[164:167], v[68:71], v[88:91]
    v_mfma_f32_16x16x32_bf16 v[92:95], v[168:171], v[64:67], 0
    v_mfma_f32_16x16x32_bf16 v[92:95], v[172:175], v[68:71], v[92:95]
    v_mfma_f32_16x16x32_bf16 v[96:99], v[176:179], v[64:67], 0
    v_mfma_f32_16x16x32_bf16 v[96:99], v[180:183], v[68:71], v[96:99]
    v_mfma_f32_16x16x32_bf16 v[100:103], v[184:187], v[64:67], 0
    v_mfma_f32_16x16x32_bf16 v[100:103], v[188:191], v[68:71], v[100:103]
    s_nop 7
    buffer_store_dwordx4 v[72:75], v14, s[52:55], 0 offen offset:0
    buffer_store_dwordx4 v[76:79], v14, s[52:55], 0 offen offset:64
    buffer_store_dwordx4 v[80:83], v14, s[52:55], 0 offen offset:128
    buffer_store_dwordx4 v[84:87], v14, s[52:55], 0 offen offset:192
    buffer_store_dwordx4 v[88:91], v14, s[52:55], 0 offen offset:256
    buffer_store_dwordx4 v[92:95], v14, s[52:55], 0 offen offset:320
    buffer_store_dwordx4 v[96:99], v14, s[52:55], 0 offen offset:384
    buffer_store_dwordx4 v[100:103], v14, s[52:55], 0 offen offset:448
L_k3s_end:
    s_endpgm
.section .rodata,"a"
.p2align 6
.amdhsa_kernel k3l0_kernel
  .amdhsa_next_free_vgpr 192
  .amdhsa_next_free_sgpr 102
  .amdhsa_accum_offset 192
  .amdhsa_group_segment_fixed_size 0
  .amdhsa_kernarg_size 88
  .amdhsa_user_sgpr_count 2
  .amdhsa_user_sgpr_kernarg_segment_ptr 1
  .amdhsa_system_sgpr_workgroup_id_x 1
.end_amdhsa_kernel
.section .rodata,"a"
.p2align 6
.amdhsa_kernel k3l1_kernel
  .amdhsa_next_free_vgpr 192
  .amdhsa_next_free_sgpr 102
  .amdhsa_accum_offset 192
  .amdhsa_group_segment_fixed_size 0
  .amdhsa_kernarg_size 88
  .amdhsa_user_sgpr_count 2
  .amdhsa_user_sgpr_kernarg_segment_ptr 1
  .amdhsa_system_sgpr_workgroup_id_x 1
.end_amdhsa_kernel

.text
.globl k4l0_kernel
.p2align 8
.type k4l0_kernel,@function
k4l0_kernel:
    s_mov_b32 s98, 0
    s_branch L_k4s_body
.globl k4l1_kernel
.p2align 8
.type k4l1_kernel,@function
k4l1_kernel:
    s_mov_b32 s98, 1
L_k4s_body:
    s_cmp_ge_u32 s2, 8
    s_cbranch_scc1 L_k4s_end
    s_load_dwordx2 s[24:25], s[0:1], 80
    s_load_dwordx2 s[26:27], s[0:1], 64
    s_waitcnt lgkmcnt(0)
    s_add_u32 s4, s24, 0x800000
    s_addc_u32 s5, s25, 0
    s_mov_b32 s6, 0x70000
    s_mov_b32 s7, 0x00020000
    s_add_u32 s8, s24, 0x200000
    s_addc_u32 s9, s25, 0
    s_mov_b32 s10, 0x200000
    s_mov_b32 s11, 0x00020000
    s_mov_b32 s96, s26
    s_mov_b32 s97, s27
    s_add_u32 s12, s24, 0x400000
    s_addc_u32 s13, s25, 0
    s_cmp_eq_u32 s98, 0
    s_cselect_b32 s12, s12, s96
    s_cselect_b32 s13, s13, s97
    s_mov_b32 s14, 0x200000
    s_mov_b32 s15, 0x00020000
    s_add_u32 s16, s24, 0x620000
    s_addc_u32 s17, s25, 0
    s_mov_b32 s18, 0x40
    s_mov_b32 s19, 0x00020000
    s_add_u32 s20, s24, 0x630000
    s_addc_u32 s21, s25, 0
    s_mov_b32 s22, 0x2000
    s_mov_b32 s23, 0x00020000
    s_lshl_b32 s3, s2, 2
    v_mov_b32 v2, s3
    buffer_load_dword v3, v2, s[16:19], 0 offen
    buffer_load_dword v4, v2, s[16:19], 0 offen offset:32
    s_lshl_b32 s3, s2, 10
    v_lshlrev_b32 v5, 2, v0
    v_add_u32 v6, s3, v5
    buffer_load_dword v7, v6, s[20:23], 0 offen
    s_lshl_b32 s3, s2, 11
    v_lshlrev_b32 v8, 3, v0
    v_add_u32 v8, s3, v8

    s_mov_b32 s3, 0
    buffer_load_dwordx2 v[16:17], v8, s[4:7], s3 offen
    s_mov_b32 s3, 16384
    buffer_load_dwordx2 v[18:19], v8, s[4:7], s3 offen
    s_mov_b32 s3, 32768
    buffer_load_dwordx2 v[20:21], v8, s[4:7], s3 offen
    s_mov_b32 s3, 49152
    buffer_load_dwordx2 v[22:23], v8, s[4:7], s3 offen
    s_mov_b32 s3, 65536
    buffer_load_dwordx2 v[24:25], v8, s[4:7], s3 offen
    s_mov_b32 s3, 81920
    buffer_load_dwordx2 v[26:27], v8, s[4:7], s3 offen
    s_mov_b32 s3, 98304
    buffer_load_dwordx2 v[28:29], v8, s[4:7], s3 offen
    s_mov_b32 s3, 114688
    buffer_load_dwordx2 v[30:31], v8, s[4:7], s3 offen
    s_mov_b32 s3, 131072
    buffer_load_dwordx2 v[32:33], v8, s[4:7], s3 offen
    s_mov_b32 s3, 147456
    buffer_load_dwordx2 v[34:35], v8, s[4:7], s3 offen
    s_mov_b32 s3, 163840
    buffer_load_dwordx2 v[36:37], v8, s[4:7], s3 offen
    s_mov_b32 s3, 180224
    buffer_load_dwordx2 v[38:39], v8, s[4:7], s3 offen
    s_mov_b32 s3, 196608
    buffer_load_dwordx2 v[40:41], v8, s[4:7], s3 offen
    s_mov_b32 s3, 212992
    buffer_load_dwordx2 v[42:43], v8, s[4:7], s3 offen
    s_mov_b32 s3, 229376
    buffer_load_dwordx2 v[44:45], v8, s[4:7], s3 offen
    s_mov_b32 s3, 245760
    buffer_load_dwordx2 v[46:47], v8, s[4:7], s3 offen
    s_mov_b32 s3, 262144
    buffer_load_dwordx2 v[48:49], v8, s[4:7], s3 offen
    s_mov_b32 s3, 278528
    buffer_load_dwordx2 v[50:51], v8, s[4:7], s3 offen
    s_mov_b32 s3, 294912
    buffer_load_dwordx2 v[52:53], v8, s[4:7], s3 offen
    s_mov_b32 s3, 311296
    buffer_load_dwordx2 v[54:55], v8, s[4:7], s3 offen
    s_mov_b32 s3, 327680
    buffer_load_dwordx2 v[56:57], v8, s[4:7], s3 offen
    s_mov_b32 s3, 344064
    buffer_load_dwordx2 v[58:59], v8, s[4:7], s3 offen
    s_mov_b32 s3, 360448
    buffer_load_dwordx2 v[60:61], v8, s[4:7], s3 offen
    s_mov_b32 s3, 376832
    buffer_load_dwordx2 v[62:63], v8, s[4:7], s3 offen
    s_mov_b32 s3, 393216
    buffer_load_dwordx2 v[64:65], v8, s[4:7], s3 offen
    s_mov_b32 s3, 409600
    buffer_load_dwordx2 v[66:67], v8, s[4:7], s3 offen
    s_mov_b32 s3, 425984
    buffer_load_dwordx2 v[68:69], v8, s[4:7], s3 offen
    s_mov_b32 s3, 442368
    buffer_load_dwordx2 v[70:71], v8, s[4:7], s3 offen
    s_waitcnt vmcnt(30)
    v_lshl_add_u32 v9, v3, 10, v5
    buffer_load_dword v10, v9, s[8:11], 0 offen
    s_waitcnt vmcnt(1)
    v_add_f32 v16, v16, v18
    v_add_f32 v17, v17, v19
    v_add_f32 v16, v16, v20
    v_add_f32 v17, v17, v21
    v_add_f32 v16, v16, v22
    v_add_f32 v17, v17, v23
    v_add_f32 v16, v16, v24
    v_add_f32 v17, v17, v25
    v_add_f32 v16, v16, v26
    v_add_f32 v17, v17, v27
    v_add_f32 v16, v16, v28
    v_add_f32 v17, v17, v29
    v_add_f32 v16, v16, v30
    v_add_f32 v17, v17, v31
    v_add_f32 v16, v16, v32
    v_add_f32 v17, v17, v33
    v_add_f32 v16, v16, v34
    v_add_f32 v17, v17, v35
    v_add_f32 v16, v16, v36
    v_add_f32 v17, v17, v37
    v_add_f32 v16, v16, v38
    v_add_f32 v17, v17, v39
    v_add_f32 v16, v16, v40
    v_add_f32 v17, v17, v41
    v_add_f32 v16, v16, v42
    v_add_f32 v17, v17, v43
    v_add_f32 v16, v16, v44
    v_add_f32 v17, v17, v45
    v_add_f32 v16, v16, v46
    v_add_f32 v17, v17, v47
    v_add_f32 v16, v16, v48
    v_add_f32 v17, v17, v49
    v_add_f32 v16, v16, v50
    v_add_f32 v17, v17, v51
    v_add_f32 v16, v16, v52
    v_add_f32 v17, v17, v53
    v_add_f32 v16, v16, v54
    v_add_f32 v17, v17, v55
    v_add_f32 v16, v16, v56
    v_add_f32 v17, v17, v57
    v_add_f32 v16, v16, v58
    v_add_f32 v17, v17, v59
    v_add_f32 v16, v16, v60
    v_add_f32 v17, v17, v61
    v_add_f32 v16, v16, v62
    v_add_f32 v17, v17, v63
    v_add_f32 v16, v16, v64
    v_add_f32 v17, v17, v65
    v_add_f32 v16, v16, v66
    v_add_f32 v17, v17, v67
    v_add_f32 v16, v16, v68
    v_add_f32 v17, v17, v69
    v_add_f32 v16, v16, v70
    v_add_f32 v17, v17, v71
    v_cvt_pk_bf16_f32 v40, v16, v17
    v_lshlrev_b32 v41, 16, v40
    v_and_b32 v42, 0xffff0000, v40
    v_mul_f32 v41, v41, v4
    v_mul_f32 v42, v42, v4
    v_cvt_pk_bf16_f32 v40, v41, v42
    v_lshlrev_b32 v41, 16, v40
    v_and_b32 v42, 0xffff0000, v40
    v_lshlrev_b32 v43, 16, v7
    v_and_b32 v44, 0xffff0000, v7
    v_add_f32 v41, v41, v43
    v_add_f32 v42, v42, v44
    v_cvt_pk_bf16_f32 v40, v41, v42
    v_lshlrev_b32 v41, 16, v40
    v_and_b32 v42, 0xffff0000, v40
    s_waitcnt vmcnt(0)
    v_lshlrev_b32 v43, 16, v10
    v_and_b32 v44, 0xffff0000, v10
    v_add_f32 v41, v41, v43
    v_add_f32 v42, v42, v44
    v_cvt_pk_bf16_f32 v40, v41, v42
    buffer_store_dword v40, v9, s[12:15], 0 offen

L_k4s_end:
    s_endpgm
.section .rodata,"a"
.p2align 6
.amdhsa_kernel k4l0_kernel
  .amdhsa_next_free_vgpr 80
  .amdhsa_next_free_sgpr 102
  .amdhsa_accum_offset 80
  .amdhsa_group_segment_fixed_size 0
  .amdhsa_kernarg_size 88
  .amdhsa_user_sgpr_count 2
  .amdhsa_user_sgpr_kernarg_segment_ptr 1
  .amdhsa_system_sgpr_workgroup_id_x 1
.end_amdhsa_kernel
.section .rodata,"a"
.p2align 6
.amdhsa_kernel k4l1_kernel
  .amdhsa_next_free_vgpr 80
  .amdhsa_next_free_sgpr 102
  .amdhsa_accum_offset 80
  .amdhsa_group_segment_fixed_size 0
  .amdhsa_kernarg_size 88
  .amdhsa_user_sgpr_count 2
  .amdhsa_user_sgpr_kernarg_segment_ptr 1
  .amdhsa_system_sgpr_workgroup_id_x 1
.end_amdhsa_kernel
```
